```python
import torch

def _softmax(x, axis=-1):
    return torch.softmax(x, dim=axis)
def _gelu(x):
    return torch.nn.functional.gelu(x, approximate="tanh")
def _silu(x):
    return torch.nn.functional.silu(x)
def _sigmoid(x):
    return torch.sigmoid(x)
def _layernorm(x, axis=-1, eps=1e-5):
    m = x.mean(dim=axis, keepdim=True)
    v = x.var(dim=axis, keepdim=True, unbiased=False)
    return (x - m) / torch.sqrt(v + eps)
def _scatter_add(tgt, idx, src, axis=0):
    return tgt.clone().index_add_(axis, idx, src)
def _segment_sum(src, seg, n):
    out = torch.zeros((n,) + src.shape[1:], dtype=src.dtype)
    return out.index_add_(0, seg, src)
def _pad(x, pw):
    flat = tuple(v for pair in reversed(pw) for v in pair)
    return torch.nn.functional.pad(x, flat)

kernel_name = 'standalone__glu_gated_geglu__sampling'

def setup_inputs():

    _w = (lambda a: (lambda t: t.to(torch.bfloat16) if t.is_floating_point() else t)(torch.as_tensor(a)))
    B, S, Dm, Df = 8, 16, 1024, 3584
    return {
        "x": _w((lambda *s: torch.randn(*s, dtype=torch.bfloat16) * 0.05)(B, S, Dm)),
        "w_gate": _w((lambda *s: torch.randn(*s, dtype=torch.bfloat16) * 0.05)(Dm, Df) * (Dm ** -0.5)),
        "w_up": _w((lambda *s: torch.randn(*s, dtype=torch.bfloat16) * 0.05)(Dm, Df) * (Dm ** -0.5)),
        "w_down": _w((lambda *s: torch.randn(*s, dtype=torch.bfloat16) * 0.05)(Df, Dm) * (Df ** -0.5)),
    }

def reference(x, w_gate, w_up, w_down):
    g = torch.einsum("bsd,df->bsf", x, w_gate)
    u = torch.einsum("bsd,df->bsf", x, w_up)
    h = _gelu(g) * u
    return torch.einsum("bsf,fd->bsd", h, w_down)
```

```asm
; @launch grid=(256,1,1) block=(512,1,1) lds=163840
.amdgcn_target "amdgcn-amd-amdhsa--gfx950"
.text
.globl standalone__glu_gated_geglu__sampling_kernel
.p2align 8
.type standalone__glu_gated_geglu__sampling_kernel,@function
standalone__glu_gated_geglu__sampling_kernel:
    s_load_dwordx2 s[24:25], s[0:1], 8
    s_load_dwordx2 s[28:29], s[0:1], 16
    s_load_dwordx2 s[20:21], s[0:1], 0
    v_lshrrev_b32 v1, 6, v0
    s_and_b32 s3, s2, 7
    v_readfirstlane_b32 s5, v1
    s_lshr_b32 s4, s2, 3
    v_and_b32 v0, 63, v0
    s_cmp_ge_u32 s4, 32
    s_cbranch_scc1 L_end
    s_mov_b32 s26, 0x700000
    s_mov_b32 s27, 0x20000
    v_lshrrev_b32 v2, 3, v0
    v_and_b32 v3, 7, v0
    s_mul_i32 s8, s3, 896
    v_mul_u32_u24 v6, 7168, v2
    s_sub_u32 s17, s5, 4
    s_cbranch_scc0 L_L
    s_sub_u32 s6, s4, 14
    s_cbranch_scc1 L_QC
    s_cmp_lg_u32 s5, 0
    s_cbranch_scc1 L_pfstub
    s_cmp_ge_u32 s6, 16
    s_cbranch_scc1 L_XC
    v_min_u32 v4, 6, v3
    s_lshr_b32 s11, s6, 1
    s_mul_i32 s7, s11, 57344
    v_lshl_add_u32 v7, v4, 7, v6
    s_add_u32 s7, s7, s8
    s_mov_b32 s13, 458752
    s_bitcmp1_b32 s6, 0
    s_waitcnt lgkmcnt(0)
    s_cselect_b32 s24, s28, s24
    s_cselect_b32 s25, s29, s25
    buffer_load_dword v251, v7, s[24:27], s7 offen
    s_add_u32 s7, s7, s13
    s_mov_b32 s22, 0x40000
    s_mov_b32 s23, s27
    v_min_u32 v4, 3, v3
    v_lshlrev_b32 v10, 11, v2
    s_lshl_b32 s12, s6, 14
    v_lshl_add_u32 v10, v4, 7, v10
    buffer_load_dword v251, v10, s[20:23], s12 offen
    buffer_load_dword v251, v7, s[24:27], s7 offen
    s_add_u32 s7, s7, s13
    buffer_load_dword v251, v7, s[24:27], s7 offen
    s_add_u32 s7, s7, s13
    s_branch L_Prest
L_pfstub:
    s_cmp_lt_u32 s6, 16
    s_cbranch_scc1 L_PC_aux
    s_getpc_b64 s[52:53]
L_pc3:
    s_lshl_b32 s12, s5, 12
    v_lshl_add_u32 v5, v0, 6, s12
    global_load_dword v251, v5, s[52:53] offset:-4096
    s_branch L_PC_aux
L_L:
    v_lshrrev_b32 v1, 4, v0
    s_cmp_ge_u32 s4, 14
    s_cbranch_scc1 L_PL
    v_and_b32 v5, 1, v1
    s_lshr_b32 s7, s4, 1
    v_lshlrev_b32 v5, 1, v5
    s_lshl_b32 s7, s7, 7
    v_xor_b32 v5, v5, v3
    s_mul_i32 s10, s17, 114688
    v_lshl_add_u32 v240, v5, 4, v6
    s_add_u32 s7, s7, s8
    s_lshl_b32 s9, s17, 12
    v_xor_b32 v241, 64, v240
    s_mov_b32 m0, s9
    s_add_u32 s7, s7, s10
    v_add_u32 v241, 56320, v241
    s_add_u32 s30, s26, 2048
    s_mov_b32 s31, s27
    s_waitcnt lgkmcnt(0)
    buffer_load_dwordx4 v240, s[24:27], s7 offen lds
    s_sub_u32 s28, s28, 2048
    s_subb_u32 s29, s29, 0
    buffer_load_dwordx4 v241, s[24:27], s7 offen offset:1024 lds
    v_xor_b32 v7, v1, v3
    v_lshlrev_b32 v6, 11, v2
    buffer_load_dwordx4 v240, s[28:31], s7 offen offset:2048 lds
    s_and_b32 s8, s4, 1
    v_lshl_add_u32 v242, v7, 4, v6
    buffer_load_dwordx4 v241, s[28:31], s7 offen offset:3072 lds
    s_lshl2_add_u32 s8, s8, s17
    s_lshr_b32 s10, s9, 1
    s_bitset1_b32 s10, 14
    s_lshl_b32 s8, s8, 15
    s_mov_b32 m0, s10
    s_mov_b32 s22, 0x40000
    s_mov_b32 s23, s27
    v_xor_b32 v243, 64, v242
    buffer_load_dwordx4 v242, s[20:23], s8 offen lds
    v_add_u32 v243, 15360, v243
    s_add_u32 s7, s7, 458752
    buffer_load_dwordx4 v243, s[20:23], s8 offen offset:1024 lds
    s_load_dwordx2 s[32:33], s[0:1], 24
    s_load_dwordx2 s[44:45], s[0:1], 48
    s_load_dwordx2 s[36:37], s[0:1], 32
    s_add_u32 m0, s9, 24576
    s_add_u32 s8, s8, 128
    buffer_load_dwordx4 v240, s[24:27], s7 offen lds
    buffer_load_dwordx4 v241, s[24:27], s7 offen offset:1024 lds
    buffer_load_dwordx4 v240, s[28:31], s7 offen offset:2048 lds
    buffer_load_dwordx4 v241, s[28:31], s7 offen offset:3072 lds
    s_add_u32 m0, s10, 24576
    s_add_u32 s7, s7, 458752
    buffer_load_dwordx4 v242, s[20:23], s8 offen lds
    buffer_load_dwordx4 v243, s[20:23], s8 offen offset:1024 lds
    s_add_u32 m0, s9, 49152
    s_add_u32 s8, s8, 128
    buffer_load_dwordx4 v240, s[24:27], s7 offen lds
    buffer_load_dwordx4 v241, s[24:27], s7 offen offset:1024 lds
    buffer_load_dwordx4 v240, s[28:31], s7 offen offset:2048 lds
    buffer_load_dwordx4 v241, s[28:31], s7 offen offset:3072 lds
    s_mov_b32 s46, 268435456
    s_mov_b32 s47, s27
    s_mov_b32 s18, 4206592
    s_waitcnt lgkmcnt(0)
    buffer_load_dword v22, off, s[44:47], s18 sc1
.p2align 3
    s_waitcnt vmcnt(10)
    s_barrier
    s_add_u32 m0, s10, 49152
    s_add_u32 s7, s7, 458752
    buffer_load_dwordx4 v242, s[20:23], s8 offen lds
    buffer_load_dwordx4 v243, s[20:23], s8 offen offset:1024 lds
    s_add_u32 m0, s9, 73728
    s_add_u32 s8, s8, 128
    buffer_load_dwordx4 v240, s[24:27], s7 offen lds
    buffer_load_dwordx4 v241, s[24:27], s7 offen offset:1024 lds
    buffer_load_dwordx4 v240, s[28:31], s7 offen offset:2048 lds
    buffer_load_dwordx4 v241, s[28:31], s7 offen offset:3072 lds
    s_waitcnt vmcnt(10)
    s_barrier
    s_add_u32 m0, s10, 73728
    s_add_u32 s7, s7, 458752
    buffer_load_dwordx4 v242, s[20:23], s8 offen lds
    buffer_load_dwordx4 v243, s[20:23], s8 offen offset:1024 lds
    s_add_u32 m0, s9, 0
    s_add_u32 s8, s8, 128
    buffer_load_dwordx4 v240, s[24:27], s7 offen lds
    buffer_load_dwordx4 v241, s[24:27], s7 offen offset:1024 lds
    buffer_load_dwordx4 v240, s[28:31], s7 offen offset:2048 lds
    buffer_load_dwordx4 v241, s[28:31], s7 offen offset:3072 lds
    s_cmp_ge_u32 s4, 30
    s_cselect_b32 s64, 16, 14
    s_cselect_b32 s6, 1, 0
    s_cmp_lt_u32 s4, 14
    s_cselect_b32 s64, 0, s64
    s_cselect_b32 s6, 1, s6
    s_sub_u32 s64, s4, s64
    s_lshl_b32 s51, s64, 1
    s_add_u32 s51, s51, s6
    s_mov_b32 s46, 268435456
    s_mov_b32 s47, 0x20000
    s_waitcnt vmcnt(10)
    s_barrier
    s_add_u32 m0, s10, 0
    s_add_u32 s7, s7, 458752
    buffer_load_dwordx4 v242, s[20:23], s8 offen lds
    buffer_load_dwordx4 v243, s[20:23], s8 offen offset:1024 lds
    s_add_u32 m0, s9, 24576
    s_add_u32 s8, s8, 128
    buffer_load_dwordx4 v240, s[24:27], s7 offen lds
    buffer_load_dwordx4 v241, s[24:27], s7 offen offset:1024 lds
    buffer_load_dwordx4 v240, s[28:31], s7 offen offset:2048 lds
    buffer_load_dwordx4 v241, s[28:31], s7 offen offset:3072 lds
    s_mov_b32 s38, 0x40000
    s_mov_b32 s39, 0x20000
    v_lshlrev_b32 v8, 4, v0
    v_lshlrev_b32 v9, 2, v0
    v_mov_b32 v18, 155648
    v_and_b32 v27, 124, v9
    s_lshl_b32 s58, s51, 3
    s_add_u32 s58, s58, s3
    s_lshl_b32 s58, s58, 3
    s_add_u32 s58, s58, s5
    s_mul_i32 s58, s58, 1152
    s_waitcnt vmcnt(10)
    s_barrier
    s_add_u32 m0, s10, 24576
    s_add_u32 s7, s7, 458752
    buffer_load_dwordx4 v242, s[20:23], s8 offen lds
    buffer_load_dwordx4 v243, s[20:23], s8 offen offset:1024 lds
    s_add_u32 m0, s9, 49152
    s_add_u32 s8, s8, 128
    buffer_load_dwordx4 v240, s[24:27], s7 offen lds
    buffer_load_dwordx4 v241, s[24:27], s7 offen offset:1024 lds
    buffer_load_dwordx4 v240, s[28:31], s7 offen offset:2048 lds
    buffer_load_dwordx4 v241, s[28:31], s7 offen offset:3072 lds
    s_add_u32 s58, s58, 5242880
    v_lshrrev_b32 v4, 3, v0
    v_add_u32 v4, v4, v0
    s_mul_i32 s12, s5, 1280
    v_lshl_add_u32 v29, v4, 4, s12
    s_getreg_b32 s65, hwreg(HW_REG_XCC_ID, 0, 4)
    s_lshl_b32 s65, s65, 28
    v_lshlrev_b32 v5, 1, v1
    v_lshlrev_b32 v6, 11, v2
    v_xor_b32 v5, v5, v3
    s_mul_i32 s61, s3, 917504
    s_waitcnt vmcnt(10)
    s_barrier
    s_add_u32 m0, s10, 49152
    s_add_u32 s7, s7, 458752
    buffer_load_dwordx4 v242, s[20:23], s8 offen lds
    buffer_load_dwordx4 v243, s[20:23], s8 offen offset:1024 lds
    s_add_u32 m0, s9, 73728
    s_add_u32 s8, s8, 128
    buffer_load_dwordx4 v240, s[24:27], s7 offen lds
    buffer_load_dwordx4 v241, s[24:27], s7 offen offset:1024 lds
    buffer_load_dwordx4 v240, s[28:31], s7 offen offset:2048 lds
    buffer_load_dwordx4 v241, s[28:31], s7 offen offset:3072 lds
    s_lshl_b32 s14, s64, 7
    v_lshl_add_u32 v244, v5, 4, v6
    s_add_u32 s61, s61, s14
    v_add_u32 v245, 15360, v244
    s_mul_i32 s14, s17, 114688
    s_mul_i32 s62, s17, 7168
    v_add_u32 v246, 30720, v244
    s_add_u32 s61, s61, s14
    s_add_u32 s62, s62, 98304
    v_add_u32 v247, 46080, v244
    s_mov_b32 s34, 0x700000
    s_waitcnt vmcnt(10)
    s_barrier
    s_add_u32 m0, s10, 73728
    s_add_u32 s7, s7, 458752
    buffer_load_dwordx4 v242, s[20:23], s8 offen lds
    buffer_load_dwordx4 v243, s[20:23], s8 offen offset:1024 lds
    s_add_u32 m0, s9, 0
    s_add_u32 s8, s8, 128
    buffer_load_dwordx4 v240, s[24:27], s7 offen lds
    buffer_load_dwordx4 v241, s[24:27], s7 offen offset:1024 lds
    buffer_load_dwordx4 v240, s[28:31], s7 offen offset:2048 lds
    buffer_load_dwordx4 v241, s[28:31], s7 offen offset:3072 lds
    s_mov_b32 s35, 0x20000
    v_lshrrev_b32 v4, 2, v0
    v_bfe_u32 v5, v0, 3, 2
    v_and_b32 v6, 3, v0
    v_lshlrev_b32 v4, 7, v4
    v_lshl_add_u32 v4, v6, 3, v4
    v_lshl_add_u32 v4, v5, 5, v4
    v_add_u32 v10, 98304, v4
    v_xor_b32 v11, 32, v10
    v_xor_b32 v12, 64, v10
    v_xor_b32 v13, 96, v10
    s_waitcnt vmcnt(10)
    s_barrier
    s_add_u32 m0, s10, 0
    s_add_u32 s7, s7, 458752
    buffer_load_dwordx4 v242, s[20:23], s8 offen lds
    buffer_load_dwordx4 v243, s[20:23], s8 offen offset:1024 lds
    s_add_u32 m0, s9, 24576
    s_add_u32 s8, s8, 128
    buffer_load_dwordx4 v240, s[24:27], s7 offen lds
    buffer_load_dwordx4 v241, s[24:27], s7 offen offset:1024 lds
    buffer_load_dwordx4 v240, s[28:31], s7 offen offset:2048 lds
    buffer_load_dwordx4 v241, s[28:31], s7 offen offset:3072 lds
    v_mov_b64 v[32:33], 0
    v_mov_b64 v[34:35], 0
    v_mov_b64 v[36:37], 0
    v_mov_b64 v[38:39], 0
    v_mov_b64 v[40:41], 0
    v_mov_b64 v[42:43], 0
    v_mov_b64 v[44:45], 0
    v_mov_b64 v[46:47], 0
    s_lshl_b32 s56, s6, 2
    s_add_u32 s56, s56, s17
    s_lshl_b32 s12, s3, 3
    s_waitcnt vmcnt(10)
    s_barrier
    s_add_u32 m0, s10, 24576
    s_add_u32 s7, s7, 458752
    buffer_load_dwordx4 v242, s[20:23], s8 offen lds
    buffer_load_dwordx4 v243, s[20:23], s8 offen offset:1024 lds
    s_add_u32 m0, s9, 49152
    s_add_u32 s8, s8, 128
    buffer_load_dwordx4 v240, s[24:27], s7 offen lds
    buffer_load_dwordx4 v241, s[24:27], s7 offen offset:1024 lds
    buffer_load_dwordx4 v240, s[28:31], s7 offen offset:2048 lds
    buffer_load_dwordx4 v241, s[28:31], s7 offen offset:3072 lds
    s_add_u32 s12, s12, s56
    s_lshl_b32 s12, s12, 7
    s_add_u32 s50, s12, 4194304
    s_mul_i32 s56, s56, 112
    s_mul_i32 s12, s3, 14
    s_add_u32 s56, s56, s12
    s_lshl_b32 s57, s56, 10
    s_lshl_b32 s59, s51, 2
    s_add_u32 s59, s59, s17
    s_lshl_b32 s59, s59, 4
    s_add_u32 s59, s59, s3
    s_waitcnt vmcnt(10)
    s_barrier
    s_add_u32 m0, s10, 49152
    s_add_u32 s7, s7, 458752
    buffer_load_dwordx4 v242, s[20:23], s8 offen lds
    buffer_load_dwordx4 v243, s[20:23], s8 offen offset:1024 lds
    s_add_u32 m0, s9, 73728
    s_add_u32 s8, s8, 128
    buffer_load_dwordx4 v240, s[24:27], s7 offen lds
    buffer_load_dwordx4 v241, s[24:27], s7 offen offset:1024 lds
    buffer_load_dwordx4 v240, s[28:31], s7 offen offset:2048 lds
    buffer_load_dwordx4 v241, s[28:31], s7 offen offset:3072 lds
    s_mul_i32 s59, s59, 1152
    s_add_u32 s59, s59, 5242880
    v_and_b32 v4, 7, v0
    v_lshl_add_u32 v4, v1, 3, v4
    v_bfe_u32 v5, v0, 3, 1
    v_mul_u32_u24 v6, 9216, v5
    v_lshl_add_u32 v14, v4, 4, v6
    v_lshl_add_u32 v15, v4, 2, v6
    v_min_u32 v19, 52, v9
    v_mov_b32 v31, 0
    v_mov_b32 v17, 1
    s_waitcnt vmcnt(10)
    s_barrier
    s_add_u32 m0, s10, 73728
    s_add_u32 s7, s7, 458752
    buffer_load_dwordx4 v242, s[20:23], s8 offen lds
    buffer_load_dwordx4 v243, s[20:23], s8 offen offset:1024 lds
    s_add_u32 m0, s9, 0
    s_add_u32 s8, s8, 128
    buffer_load_dwordx4 v240, s[24:27], s7 offen lds
    buffer_load_dwordx4 v241, s[24:27], s7 offen offset:1024 lds
    buffer_load_dwordx4 v240, s[28:31], s7 offen offset:2048 lds
    buffer_load_dwordx4 v241, s[28:31], s7 offen offset:3072 lds
    s_lshl_b32 s12, s3, 2
    s_lshr_b32 s13, s4, 3
    s_add_u32 s12, s12, s13
    s_lshl_b32 s12, s12, 5
    s_and_b32 s13, s4, 7
    s_add_u32 s12, s12, s13
    s_lshl_b32 s12, s12, 2
    s_add_u32 s12, s12, 4210688
    s_cmp_eq_u32 s5, 4
    s_cselect_b32 s60, s12, s46
    s_lshl_b32 s12, s17, 1
    s_waitcnt vmcnt(10)
    s_barrier
    s_add_u32 m0, s10, 0
    s_add_u32 s7, s7, 458752
    buffer_load_dwordx4 v242, s[20:23], s8 offen lds
    buffer_load_dwordx4 v243, s[20:23], s8 offen offset:1024 lds
    s_add_u32 m0, s9, 24576
    s_add_u32 s8, s8, 128
    buffer_load_dwordx4 v240, s[24:27], s7 offen lds
    buffer_load_dwordx4 v241, s[24:27], s7 offen offset:1024 lds
    buffer_load_dwordx4 v240, s[28:31], s7 offen offset:2048 lds
    buffer_load_dwordx4 v241, s[28:31], s7 offen offset:3072 lds
    v_add_u32 v5, s12, v5
    v_cmp_eq_u32 s[66:67], s3, v5
    v_add_u32 v6, v4, v1
    s_mul_i32 s12, s3, 1280
    v_mov_b32 v5, s46
    v_lshl_add_u32 v28, v6, 4, s12
    v_cndmask_b32 v14, v14, v5, s[66:67]
    v_cndmask_b32 v15, v15, v5, s[66:67]
    s_waitcnt vmcnt(10)
    s_barrier
    s_add_u32 m0, s10, 24576
    s_add_u32 s7, s7, 458752
    buffer_load_dwordx4 v242, s[20:23], s8 offen lds
    buffer_load_dwordx4 v243, s[20:23], s8 offen offset:1024 lds
    s_add_u32 m0, s9, 49152
    s_add_u32 s8, s8, 128
    buffer_load_dwordx4 v240, s[24:27], s7 offen lds
    buffer_load_dwordx4 v241, s[24:27], s7 offen offset:1024 lds
    buffer_load_dwordx4 v240, s[28:31], s7 offen offset:2048 lds
    buffer_load_dwordx4 v241, s[28:31], s7 offen offset:3072 lds
    s_waitcnt vmcnt(10)
    s_barrier
    s_add_u32 m0, s10, 49152
    s_add_u32 s7, s7, 458752
    buffer_load_dwordx4 v242, s[20:23], s8 offen lds
    buffer_load_dwordx4 v243, s[20:23], s8 offen offset:1024 lds
    s_add_u32 m0, s9, 73728
    s_add_u32 s8, s8, 128
    buffer_load_dwordx4 v240, s[24:27], s7 offen lds
    buffer_load_dwordx4 v241, s[24:27], s7 offen offset:1024 lds
    buffer_load_dwordx4 v240, s[28:31], s7 offen offset:2048 lds
    buffer_load_dwordx4 v241, s[28:31], s7 offen offset:3072 lds
    s_waitcnt vmcnt(10)
    s_barrier
    s_add_u32 m0, s10, 73728
    s_add_u32 s7, s7, 458752
    buffer_load_dwordx4 v242, s[20:23], s8 offen lds
    buffer_load_dwordx4 v243, s[20:23], s8 offen offset:1024 lds
    s_waitcnt vmcnt(6)
    s_barrier
    v_add_u32 v3, 1, v22
L_Lgo:
    s_mov_b32 m0, s62
    s_waitcnt vmcnt(0) lgkmcnt(0)
    s_barrier
L_Lgo2:
    buffer_load_dwordx4 v244, s[32:35], s61 offen offset:0 lds
    buffer_load_dwordx4 v245, s[32:35], s61 offen offset:1024 lds
    buffer_load_dwordx4 v246, s[32:35], s61 offen offset:2048 lds
    buffer_load_dwordx4 v247, s[32:35], s61 offen offset:3072 lds
    s_add_u32 m0, s62, 4096
    s_add_u32 s61, s61, 65536
    buffer_load_dwordx4 v244, s[32:35], s61 offen offset:0 lds
    buffer_load_dwordx4 v245, s[32:35], s61 offen offset:1024 lds
    buffer_load_dwordx4 v246, s[32:35], s61 offen offset:2048 lds
    s_mov_b32 s13, 0
    s_add_u32 s61, s61, 393216
    v_readfirstlane_b32 s16, v3
    v_add_u32 v4, s65, v3
    s_add_u32 m0, s62, 28672
    buffer_store_dword v4, off, s[44:47], s60 sc1
    s_mov_b64 exec, 1
    s_add_u32 s65, s65, s16
    s_waitcnt vmcnt(1)
    ds_add_u32 v18, v17 offset:16
    s_mov_b64 exec, -1
L_wd_sync:
    ds_read_b32 v4, v18 offset:16
    s_waitcnt lgkmcnt(0)
    v_cmp_gt_u32 vcc, 4, v4
    s_cbranch_vccnz L_wd_sync
    ds_read_b64_tr_b16 v[48:49], v10 offset:0
    ds_read_b64_tr_b16 v[50:51], v10 offset:2048
    ds_read_b64_tr_b16 v[52:53], v11 offset:0
    ds_read_b64_tr_b16 v[54:55], v11 offset:2048
    ds_read_b64_tr_b16 v[56:57], v12 offset:0
    ds_read_b64_tr_b16 v[58:59], v12 offset:2048
    ds_read_b64_tr_b16 v[60:61], v13 offset:0
    ds_read_b64_tr_b16 v[62:63], v13 offset:2048
    s_waitcnt lgkmcnt(7)
    ds_read_b64_tr_b16 v[64:65], v10 offset:4096
    ds_read_b64_tr_b16 v[66:67], v10 offset:6144
    ds_read_b64_tr_b16 v[68:69], v11 offset:4096
    ds_read_b64_tr_b16 v[70:71], v11 offset:6144
    ds_read_b64_tr_b16 v[72:73], v12 offset:4096
    ds_read_b64_tr_b16 v[74:75], v12 offset:6144
    ds_read_b64_tr_b16 v[76:77], v13 offset:4096
    ds_read_b64_tr_b16 v[78:79], v13 offset:6144
    s_waitcnt lgkmcnt(7)
    ds_read_b64_tr_b16 v[80:81], v10 offset:8192
    ds_read_b64_tr_b16 v[82:83], v10 offset:10240
    ds_read_b64_tr_b16 v[84:85], v11 offset:8192
    ds_read_b64_tr_b16 v[86:87], v11 offset:10240
    ds_read_b64_tr_b16 v[88:89], v12 offset:8192
    ds_read_b64_tr_b16 v[90:91], v12 offset:10240
    ds_read_b64_tr_b16 v[92:93], v13 offset:8192
    ds_read_b64_tr_b16 v[94:95], v13 offset:10240
    s_waitcnt lgkmcnt(7)
    ds_read_b64_tr_b16 v[96:97], v10 offset:12288
    ds_read_b64_tr_b16 v[98:99], v10 offset:14336
    ds_read_b64_tr_b16 v[100:101], v11 offset:12288
    ds_read_b64_tr_b16 v[102:103], v11 offset:14336
    ds_read_b64_tr_b16 v[104:105], v12 offset:12288
    ds_read_b64_tr_b16 v[106:107], v12 offset:14336
    ds_read_b64_tr_b16 v[108:109], v13 offset:12288
    ds_read_b64_tr_b16 v[110:111], v13 offset:14336
    s_waitcnt lgkmcnt(7)
    ds_read_b64_tr_b16 v[112:113], v10 offset:16384
    ds_read_b64_tr_b16 v[114:115], v10 offset:18432
    ds_read_b64_tr_b16 v[116:117], v11 offset:16384
    ds_read_b64_tr_b16 v[118:119], v11 offset:18432
    ds_read_b64_tr_b16 v[120:121], v12 offset:16384
    ds_read_b64_tr_b16 v[122:123], v12 offset:18432
    ds_read_b64_tr_b16 v[124:125], v13 offset:16384
    ds_read_b64_tr_b16 v[126:127], v13 offset:18432
    s_waitcnt lgkmcnt(7)
    ds_read_b64_tr_b16 v[128:129], v10 offset:20480
    ds_read_b64_tr_b16 v[130:131], v10 offset:22528
    ds_read_b64_tr_b16 v[132:133], v11 offset:20480
    ds_read_b64_tr_b16 v[134:135], v11 offset:22528
    ds_read_b64_tr_b16 v[136:137], v12 offset:20480
    ds_read_b64_tr_b16 v[138:139], v12 offset:22528
    ds_read_b64_tr_b16 v[140:141], v13 offset:20480
    ds_read_b64_tr_b16 v[142:143], v13 offset:22528
    s_waitcnt lgkmcnt(7)
    ds_read_b64_tr_b16 v[144:145], v10 offset:24576
    ds_read_b64_tr_b16 v[146:147], v10 offset:26624
    ds_read_b64_tr_b16 v[148:149], v11 offset:24576
    ds_read_b64_tr_b16 v[150:151], v11 offset:26624
    ds_read_b64_tr_b16 v[152:153], v12 offset:24576
    ds_read_b64_tr_b16 v[154:155], v12 offset:26624
    ds_read_b64_tr_b16 v[156:157], v13 offset:24576
    ds_read_b64_tr_b16 v[158:159], v13 offset:26624
L_hs_sync:
    s_sleep 1
    ds_read_b32 v4, v18 offset:28
    s_waitcnt lgkmcnt(0)
    v_cmp_gt_u32 vcc, 4, v4
    s_cbranch_vccnz L_hs_sync
    buffer_load_dwordx4 v244, s[32:35], s61 offen offset:0 lds
    buffer_load_dwordx4 v245, s[32:35], s61 offen offset:1024 lds
    buffer_load_dwordx4 v246, s[32:35], s61 offen offset:2048 lds
    buffer_load_dwordx4 v247, s[32:35], s61 offen offset:3072 lds
    s_add_u32 m0, s62, 32768
    s_add_u32 s61, s61, 65536
    buffer_load_dwordx4 v244, s[32:35], s61 offen offset:0 lds
    buffer_load_dwordx4 v245, s[32:35], s61 offen offset:1024 lds
    buffer_load_dwordx4 v246, s[32:35], s61 offen offset:2048 lds
    buffer_load_dword v5, v19, s[44:47], s50 offen sc1
    s_mov_b64 exec, 1
    s_waitcnt vmcnt(1)
    ds_add_u32 v18, v17 offset:24
    s_mov_b64 exec, -1
    s_branch L_flag_chk
L_flag_loop:
    buffer_load_dword v5, v19, s[44:47], s50 offen sc1
    s_add_u32 s13, s13, 1
    s_cmp_gt_u32 s13, 160
    s_cbranch_scc1 L_slow
L_flag_chk:
    s_waitcnt vmcnt(0)
    v_cmp_ne_u32 vcc, s65, v5
    s_cbranch_vccnz L_flag_loop
L_flag_done:
.p2align 3
    buffer_load_dwordx4 v[176:179], v8, s[44:47], s57 offen offset:0 sc1
    buffer_load_dwordx4 v[180:183], v8, s[44:47], s57 offen offset:1024 sc1
    buffer_load_dwordx4 v[184:187], v8, s[44:47], s57 offen offset:2048 sc1
    buffer_load_dwordx4 v[188:191], v8, s[44:47], s57 offen offset:3072 sc1
    s_add_u32 s57, s57, 4096
    buffer_load_dwordx4 v[192:195], v8, s[44:47], s57 offen offset:0 sc1
L_wd_sync2:
    ds_read_b32 v4, v18 offset:24
    s_waitcnt lgkmcnt(0)
    v_cmp_gt_u32 vcc, 4, v4
    s_cbranch_vccnz L_wd_sync2
    s_waitcnt lgkmcnt(7)
    ds_read_b64_tr_b16 v[160:161], v10 offset:28672
    ds_read_b64_tr_b16 v[162:163], v10 offset:30720
    ds_read_b64_tr_b16 v[164:165], v11 offset:28672
    ds_read_b64_tr_b16 v[166:167], v11 offset:30720
    ds_read_b64_tr_b16 v[168:169], v12 offset:28672
    ds_read_b64_tr_b16 v[170:171], v12 offset:30720
    ds_read_b64_tr_b16 v[172:173], v13 offset:28672
    ds_read_b64_tr_b16 v[174:175], v13 offset:30720
L_P2:
    s_waitcnt vmcnt(4) lgkmcnt(0)
    v_mfma_f32_16x16x32_bf16 v[32:35], v[48:51], v[176:179], v[32:35]
    buffer_load_dwordx4 v[196:199], v8, s[44:47], s57 offen offset:1024 sc1
    ds_read_b64_tr_b16 v[48:49], v10 offset:32768
    ds_read_b64_tr_b16 v[50:51], v10 offset:34816
    v_mfma_f32_16x16x32_bf16 v[36:39], v[52:55], v[176:179], v[36:39]
    ds_read_b64_tr_b16 v[52:53], v11 offset:32768
    ds_read_b64_tr_b16 v[54:55], v11 offset:34816
    v_mfma_f32_16x16x32_bf16 v[40:43], v[56:59], v[176:179], v[40:43]
    ds_read_b64_tr_b16 v[56:57], v12 offset:32768
    ds_read_b64_tr_b16 v[58:59], v12 offset:34816
    v_mfma_f32_16x16x32_bf16 v[44:47], v[60:63], v[176:179], v[44:47]
    ds_read_b64_tr_b16 v[60:61], v13 offset:32768
    ds_read_b64_tr_b16 v[62:63], v13 offset:34816
    s_waitcnt vmcnt(4)
    v_mfma_f32_16x16x32_bf16 v[32:35], v[64:67], v[180:183], v[32:35]
    buffer_load_dwordx4 v[200:203], v8, s[44:47], s57 offen offset:2048 sc1
    s_waitcnt lgkmcnt(7)
    ds_read_b64_tr_b16 v[64:65], v10 offset:36864
    ds_read_b64_tr_b16 v[66:67], v10 offset:38912
    v_mfma_f32_16x16x32_bf16 v[36:39], v[68:71], v[180:183], v[36:39]
    ds_read_b64_tr_b16 v[68:69], v11 offset:36864
    ds_read_b64_tr_b16 v[70:71], v11 offset:38912
    v_mfma_f32_16x16x32_bf16 v[40:43], v[72:75], v[180:183], v[40:43]
    ds_read_b64_tr_b16 v[72:73], v12 offset:36864
    ds_read_b64_tr_b16 v[74:75], v12 offset:38912
    v_mfma_f32_16x16x32_bf16 v[44:47], v[76:79], v[180:183], v[44:47]
    ds_read_b64_tr_b16 v[76:77], v13 offset:36864
    ds_read_b64_tr_b16 v[78:79], v13 offset:38912
    s_waitcnt vmcnt(4)
    v_mfma_f32_16x16x32_bf16 v[32:35], v[80:83], v[184:187], v[32:35]
    buffer_load_dwordx4 v[204:207], v8, s[44:47], s57 offen offset:3072 sc1
    s_waitcnt lgkmcnt(7)
    ds_read_b64_tr_b16 v[80:81], v10 offset:40960
    ds_read_b64_tr_b16 v[82:83], v10 offset:43008
    v_mfma_f32_16x16x32_bf16 v[36:39], v[84:87], v[184:187], v[36:39]
    ds_read_b64_tr_b16 v[84:85], v11 offset:40960
    ds_read_b64_tr_b16 v[86:87], v11 offset:43008
    v_mfma_f32_16x16x32_bf16 v[40:43], v[88:91], v[184:187], v[40:43]
    ds_read_b64_tr_b16 v[88:89], v12 offset:40960
    ds_read_b64_tr_b16 v[90:91], v12 offset:43008
    v_mfma_f32_16x16x32_bf16 v[44:47], v[92:95], v[184:187], v[44:47]
    ds_read_b64_tr_b16 v[92:93], v13 offset:40960
    ds_read_b64_tr_b16 v[94:95], v13 offset:43008
    s_waitcnt vmcnt(4)
    v_mfma_f32_16x16x32_bf16 v[32:35], v[96:99], v[188:191], v[32:35]
    s_add_u32 s57, s57, 4096
    buffer_load_dwordx4 v[208:211], v8, s[44:47], s57 offen offset:0 sc1
    s_waitcnt lgkmcnt(7)
    ds_read_b64_tr_b16 v[96:97], v10 offset:45056
    ds_read_b64_tr_b16 v[98:99], v10 offset:47104
    v_mfma_f32_16x16x32_bf16 v[36:39], v[100:103], v[188:191], v[36:39]
    ds_read_b64_tr_b16 v[100:101], v11 offset:45056
    ds_read_b64_tr_b16 v[102:103], v11 offset:47104
    v_mfma_f32_16x16x32_bf16 v[40:43], v[104:107], v[188:191], v[40:43]
    ds_read_b64_tr_b16 v[104:105], v12 offset:45056
    ds_read_b64_tr_b16 v[106:107], v12 offset:47104
    v_mfma_f32_16x16x32_bf16 v[44:47], v[108:111], v[188:191], v[44:47]
    ds_read_b64_tr_b16 v[108:109], v13 offset:45056
    ds_read_b64_tr_b16 v[110:111], v13 offset:47104
    s_waitcnt vmcnt(4)
    v_mfma_f32_16x16x32_bf16 v[32:35], v[112:115], v[192:195], v[32:35]
    buffer_load_dwordx4 v[212:215], v8, s[44:47], s57 offen offset:1024 sc1
    s_waitcnt lgkmcnt(7)
    ds_read_b64_tr_b16 v[112:113], v10 offset:49152
    ds_read_b64_tr_b16 v[114:115], v10 offset:51200
    v_mfma_f32_16x16x32_bf16 v[36:39], v[116:119], v[192:195], v[36:39]
    ds_read_b64_tr_b16 v[116:117], v11 offset:49152
    ds_read_b64_tr_b16 v[118:119], v11 offset:51200
    v_mfma_f32_16x16x32_bf16 v[40:43], v[120:123], v[192:195], v[40:43]
    ds_read_b64_tr_b16 v[120:121], v12 offset:49152
    ds_read_b64_tr_b16 v[122:123], v12 offset:51200
    v_mfma_f32_16x16x32_bf16 v[44:47], v[124:127], v[192:195], v[44:47]
    ds_read_b64_tr_b16 v[124:125], v13 offset:49152
    ds_read_b64_tr_b16 v[126:127], v13 offset:51200
    s_waitcnt vmcnt(4)
    v_mfma_f32_16x16x32_bf16 v[32:35], v[128:131], v[196:199], v[32:35]
    buffer_load_dwordx4 v[216:219], v8, s[44:47], s57 offen offset:2048 sc1
    s_waitcnt lgkmcnt(7)
    ds_read_b64_tr_b16 v[128:129], v10 offset:53248
    ds_read_b64_tr_b16 v[130:131], v10 offset:55296
    v_mfma_f32_16x16x32_bf16 v[36:39], v[132:135], v[196:199], v[36:39]
    ds_read_b64_tr_b16 v[132:133], v11 offset:53248
    ds_read_b64_tr_b16 v[134:135], v11 offset:55296
    v_mfma_f32_16x16x32_bf16 v[40:43], v[136:139], v[196:199], v[40:43]
    ds_read_b64_tr_b16 v[136:137], v12 offset:53248
    ds_read_b64_tr_b16 v[138:139], v12 offset:55296
    v_mfma_f32_16x16x32_bf16 v[44:47], v[140:143], v[196:199], v[44:47]
    ds_read_b64_tr_b16 v[140:141], v13 offset:53248
    ds_read_b64_tr_b16 v[142:143], v13 offset:55296
    s_waitcnt vmcnt(4)
    v_mfma_f32_16x16x32_bf16 v[32:35], v[144:147], v[200:203], v[32:35]
    buffer_load_dwordx4 v[220:223], v8, s[44:47], s57 offen offset:3072 sc1
    v_mfma_f32_16x16x32_bf16 v[36:39], v[148:151], v[200:203], v[36:39]
    v_mfma_f32_16x16x32_bf16 v[40:43], v[152:155], v[200:203], v[40:43]
    v_mfma_f32_16x16x32_bf16 v[44:47], v[156:159], v[200:203], v[44:47]
    s_waitcnt vmcnt(4)
    v_mfma_f32_16x16x32_bf16 v[32:35], v[160:163], v[204:207], v[32:35]
    s_add_u32 s57, s57, 4096
    buffer_load_dwordx4 v[224:227], v8, s[44:47], s57 offen offset:0 sc1
    v_mfma_f32_16x16x32_bf16 v[36:39], v[164:167], v[204:207], v[36:39]
    v_mfma_f32_16x16x32_bf16 v[40:43], v[168:171], v[204:207], v[40:43]
    v_mfma_f32_16x16x32_bf16 v[44:47], v[172:175], v[204:207], v[44:47]
    s_waitcnt vmcnt(4) lgkmcnt(0)
    v_mfma_f32_16x16x32_bf16 v[32:35], v[48:51], v[208:211], v[32:35]
    buffer_load_dwordx4 v[228:231], v8, s[44:47], s57 offen offset:1024 sc1
    v_mfma_f32_16x16x32_bf16 v[36:39], v[52:55], v[208:211], v[36:39]
    v_mfma_f32_16x16x32_bf16 v[40:43], v[56:59], v[208:211], v[40:43]
    v_mfma_f32_16x16x32_bf16 v[44:47], v[60:63], v[208:211], v[44:47]
    s_waitcnt vmcnt(4)
    v_mfma_f32_16x16x32_bf16 v[32:35], v[64:67], v[212:215], v[32:35]
    v_mfma_f32_16x16x32_bf16 v[36:39], v[68:71], v[212:215], v[36:39]
    v_mfma_f32_16x16x32_bf16 v[40:43], v[72:75], v[212:215], v[40:43]
    v_mfma_f32_16x16x32_bf16 v[44:47], v[76:79], v[212:215], v[44:47]
    s_waitcnt vmcnt(3)
    v_mfma_f32_16x16x32_bf16 v[32:35], v[80:83], v[216:219], v[32:35]
    v_mfma_f32_16x16x32_bf16 v[36:39], v[84:87], v[216:219], v[36:39]
    v_mfma_f32_16x16x32_bf16 v[40:43], v[88:91], v[216:219], v[40:43]
    v_mfma_f32_16x16x32_bf16 v[44:47], v[92:95], v[216:219], v[44:47]
    s_waitcnt vmcnt(2)
    v_mfma_f32_16x16x32_bf16 v[32:35], v[96:99], v[220:223], v[32:35]
    v_mfma_f32_16x16x32_bf16 v[36:39], v[100:103], v[220:223], v[36:39]
    v_mfma_f32_16x16x32_bf16 v[40:43], v[104:107], v[220:223], v[40:43]
    v_mfma_f32_16x16x32_bf16 v[44:47], v[108:111], v[220:223], v[44:47]
    s_waitcnt vmcnt(1)
    v_mfma_f32_16x16x32_bf16 v[32:35], v[112:115], v[224:227], v[32:35]
    v_mfma_f32_16x16x32_bf16 v[36:39], v[116:119], v[224:227], v[36:39]
    v_mfma_f32_16x16x32_bf16 v[40:43], v[120:123], v[224:227], v[40:43]
    v_mfma_f32_16x16x32_bf16 v[44:47], v[124:127], v[224:227], v[44:47]
    s_waitcnt vmcnt(0)
    v_mfma_f32_16x16x32_bf16 v[32:35], v[128:131], v[228:231], v[32:35]
    v_mfma_f32_16x16x32_bf16 v[36:39], v[132:135], v[228:231], v[36:39]
    v_mfma_f32_16x16x32_bf16 v[40:43], v[136:139], v[228:231], v[40:43]
    v_mfma_f32_16x16x32_bf16 v[44:47], v[140:143], v[228:231], v[44:47]
    s_nop 4
    v_cvt_pk_bf16_f32 v48, v32, v33
    v_cvt_pk_bf16_f32 v49, v34, v35
    v_cvt_pk_bf16_f32 v50, v36, v37
    v_cvt_pk_bf16_f32 v51, v38, v39
    buffer_store_dwordx4 v[48:51], v14, s[44:47], s59 offen sc1
    v_cvt_pk_bf16_f32 v52, v40, v41
    v_cvt_pk_bf16_f32 v53, v42, v43
    v_cvt_pk_bf16_f32 v54, v44, v45
    v_cvt_pk_bf16_f32 v55, v46, v47
    buffer_store_dwordx4 v[52:55], v14, s[44:47], s59 offen offset:512 sc1
    v_bitop3_b32 v56, v48, v49, s16 bitop3:0x96
    v_bitop3_b32 v57, v50, v51, v52 bitop3:0x96
    v_bitop3_b32 v58, v53, v54, v55 bitop3:0x96
    v_bitop3_b32 v56, v56, v57, v58 bitop3:0x96
    buffer_store_dword v56, v15, s[44:47], s59 offen offset:1024 sc1
    s_mov_b64 exec, s[66:67]
    ds_write_b128 v28, v[48:51]
    ds_write_b128 v28, v[52:55] offset:576
    s_mov_b64 exec, 1
    ds_add_u32 v18, v17 offset:20
    s_mov_b64 exec, -1
L_fin:
    s_mov_b32 s13, 0
    s_cmp_eq_u32 s5, s3
    s_cbranch_scc1 L_fin_bar
L_fin_poll:
    buffer_load_dwordx4 v[20:23], v8, s[44:47], s58 offen sc1
    buffer_load_dword v24, v27, s[44:47], s58 offen offset:1024 sc1
    s_add_u32 s13, s13, 1
    s_cmp_gt_u32 s13, 65536
    s_cbranch_scc1 L_fin_bar
L_fin_chk:
    s_waitcnt vmcnt(0)
    v_xor_b32 v4, v20, v21
    v_bitop3_b32 v4, v4, v22, v23 bitop3:0x96
    v_mov_b32 v5, v4
    s_nop 1
    v_permlane32_swap_b32 v4, v5
    v_bitop3_b32 v4, v4, v5, v24 bitop3:0x96
    v_cmp_ne_u32 vcc, s16, v4
    s_cbranch_vccnz L_fin_poll
    ds_write_b128 v29, v[20:23]
L_fin_bar:
    s_cmp_ge_u32 s5, 4
    s_waitcnt lgkmcnt(0)
    s_barrier
    s_cbranch_scc1 L_end
    ds_read2st64_b32 v[20:21], v30 offset0:0 offset1:5
    ds_read2st64_b32 v[22:23], v30 offset0:10 offset1:15
    ds_read2st64_b32 v[24:25], v30 offset0:20 offset1:25
    ds_read2st64_b32 v[26:27], v30 offset0:30 offset1:35
    s_waitcnt lgkmcnt(3)
    v_lshlrev_b32 v32, 16, v20
    v_and_b32 v33, 0xffff0000, v20
    v_lshlrev_b32 v34, 16, v21
    v_and_b32 v35, 0xffff0000, v21
    v_pk_add_f32 v[32:33], v[32:33], v[34:35]
    s_waitcnt lgkmcnt(2)
    v_lshlrev_b32 v36, 16, v22
    v_and_b32 v37, 0xffff0000, v22
    v_lshlrev_b32 v38, 16, v23
    v_and_b32 v39, 0xffff0000, v23
    v_pk_add_f32 v[36:37], v[36:37], v[38:39]
    v_pk_add_f32 v[32:33], v[32:33], v[36:37]
    s_waitcnt lgkmcnt(1)
    v_lshlrev_b32 v40, 16, v24
    v_and_b32 v41, 0xffff0000, v24
    v_lshlrev_b32 v42, 16, v25
    v_and_b32 v43, 0xffff0000, v25
    v_pk_add_f32 v[40:41], v[40:41], v[42:43]
    s_waitcnt lgkmcnt(0)
    v_lshlrev_b32 v44, 16, v26
    v_and_b32 v45, 0xffff0000, v26
    v_lshlrev_b32 v46, 16, v27
    v_and_b32 v47, 0xffff0000, v27
    v_pk_add_f32 v[44:45], v[44:45], v[46:47]
    v_pk_add_f32 v[40:41], v[40:41], v[44:45]
    v_pk_add_f32 v[32:33], v[32:33], v[40:41]
    v_cvt_pk_bf16_f32 v4, v32, v33
    buffer_store_dword v4, v31, s[36:39], s14 offen
L_end:
    s_endpgm
L_Prest:
    s_load_dwordx2 s[32:33], s[0:1], 24
    s_load_dwordx2 s[44:45], s[0:1], 48
    s_load_dwordx2 s[36:37], s[0:1], 32
    buffer_load_dword v251, v7, s[24:27], s7 offen
    s_mov_b32 s19, s11
    s_add_u32 s7, s7, s13
    s_mov_b32 s46, 268435456
    s_mov_b32 s47, 0x20000
    s_mov_b32 s18, 4206592
    s_mov_b32 s22, 0x40000
    s_mov_b32 s23, 0x20000
    s_add_u32 s19, s19, 3
    s_and_b32 s19, s19, 7
    s_sub_u32 s15, s19, s11
    s_mul_i32 s15, s15, 57344
    s_add_u32 s15, s15, s7
    buffer_load_dword v251, v7, s[24:27], s15 offen
    s_add_u32 s7, s7, s13
    s_add_u32 s19, s19, 3
    s_and_b32 s19, s19, 7
    s_sub_u32 s15, s19, s11
    s_mul_i32 s15, s15, 57344
    s_add_u32 s15, s15, s7
    buffer_load_dword v251, v7, s[24:27], s15 offen
    s_add_u32 s7, s7, s13
    s_add_u32 s19, s19, 3
    s_and_b32 s19, s19, 7
    s_sub_u32 s15, s19, s11
    s_mul_i32 s15, s15, 57344
    s_add_u32 s15, s15, s7
    buffer_load_dword v251, v7, s[24:27], s15 offen
    s_add_u32 s7, s7, s13
    s_add_u32 s19, s19, 3
    s_and_b32 s19, s19, 7
    s_sub_u32 s15, s19, s11
    s_mul_i32 s15, s15, 57344
    s_add_u32 s15, s15, s7
    buffer_load_dword v251, v7, s[24:27], s15 offen
    s_add_u32 s7, s7, s13
    s_add_u32 s19, s19, 3
    s_and_b32 s19, s19, 7
    s_sub_u32 s15, s19, s11
    s_mul_i32 s15, s15, 57344
    s_add_u32 s15, s15, s7
    buffer_load_dword v251, v7, s[24:27], s15 offen
    s_add_u32 s7, s7, s13
    s_add_u32 s19, s19, 3
    s_and_b32 s19, s19, 7
    s_sub_u32 s15, s19, s11
    s_mul_i32 s15, s15, 57344
    s_add_u32 s15, s15, s7
    buffer_load_dword v251, v7, s[24:27], s15 offen
    s_add_u32 s7, s7, s13
    s_add_u32 s19, s19, 3
    s_and_b32 s19, s19, 7
    s_sub_u32 s15, s19, s11
    s_mul_i32 s15, s15, 57344
    s_add_u32 s15, s15, s7
    buffer_load_dword v251, v7, s[24:27], s15 offen
    s_add_u32 s7, s7, s13
    s_add_u32 s19, s19, 3
    s_and_b32 s19, s19, 7
    s_sub_u32 s15, s19, s11
    s_mul_i32 s15, s15, 57344
    s_add_u32 s15, s15, s7
    buffer_load_dword v251, v7, s[24:27], s15 offen
    s_add_u32 s7, s7, s13
    s_add_u32 s19, s19, 3
    s_and_b32 s19, s19, 7
    s_sub_u32 s15, s19, s11
    s_mul_i32 s15, s15, 57344
    s_add_u32 s15, s15, s7
    buffer_load_dword v251, v7, s[24:27], s15 offen
    s_add_u32 s7, s7, s13
    s_add_u32 s19, s19, 3
    s_and_b32 s19, s19, 7
    s_sub_u32 s15, s19, s11
    s_mul_i32 s15, s15, 57344
    s_add_u32 s15, s15, s7
    buffer_load_dword v251, v7, s[24:27], s15 offen
    s_add_u32 s7, s7, s13
    s_add_u32 s19, s19, 3
    s_and_b32 s19, s19, 7
    s_sub_u32 s15, s19, s11
    s_mul_i32 s15, s15, 57344
    s_add_u32 s15, s15, s7
    buffer_load_dword v251, v7, s[24:27], s15 offen
    s_add_u32 s7, s7, s13
    s_add_u32 s19, s19, 3
    s_and_b32 s19, s19, 7
    s_sub_u32 s15, s19, s11
    s_mul_i32 s15, s15, 57344
    s_add_u32 s15, s15, s7
    buffer_load_dword v251, v7, s[24:27], s15 offen
    s_waitcnt lgkmcnt(0)
    buffer_load_dword v22, off, s[44:47], s18 sc1

    s_mov_b32 s34, 0x700000
    s_mov_b32 s35, 0x20000
    s_mul_i32 s9, s3, 917504
    s_lshl_b32 s8, s6, 13
    s_add_u32 s9, s9, s8
    v_lshlrev_b32 v5, 7, v0
    s_add_u32 s15, s6, 0
    s_and_b32 s15, s15, 15
    s_sub_u32 s15, s15, s6
    s_lshl_b32 s15, s15, 13
    s_add_u32 s15, s15, s9
    buffer_load_dword v251, v5, s[32:35], s15 offen
    s_add_u32 s9, s9, 131072
    s_add_u32 s15, s6, 5
    s_and_b32 s15, s15, 15
    s_sub_u32 s15, s15, s6
    s_lshl_b32 s15, s15, 13
    s_add_u32 s15, s15, s9
    buffer_load_dword v251, v5, s[32:35], s15 offen
    s_add_u32 s9, s9, 131072
    s_add_u32 s15, s6, 10
    s_and_b32 s15, s15, 15
    s_sub_u32 s15, s15, s6
    s_lshl_b32 s15, s15, 13
    s_add_u32 s15, s15, s9
    buffer_load_dword v251, v5, s[32:35], s15 offen
    s_add_u32 s9, s9, 131072
    s_add_u32 s15, s6, 15
    s_and_b32 s15, s15, 15
    s_sub_u32 s15, s15, s6
    s_lshl_b32 s15, s15, 13
    s_add_u32 s15, s15, s9
    buffer_load_dword v251, v5, s[32:35], s15 offen
    s_add_u32 s9, s9, 131072
    s_add_u32 s15, s6, 20
    s_and_b32 s15, s15, 15
    s_sub_u32 s15, s15, s6
    s_lshl_b32 s15, s15, 13
    s_add_u32 s15, s15, s9
    buffer_load_dword v251, v5, s[32:35], s15 offen
    s_add_u32 s9, s9, 131072
    s_add_u32 s15, s6, 25
    s_and_b32 s15, s15, 15
    s_sub_u32 s15, s15, s6
    s_lshl_b32 s15, s15, 13
    s_add_u32 s15, s15, s9
    buffer_load_dword v251, v5, s[32:35], s15 offen
    s_add_u32 s9, s9, 131072
    s_add_u32 s15, s6, 30
    s_and_b32 s15, s15, 15
    s_sub_u32 s15, s15, s6
    s_lshl_b32 s15, s15, 13
    s_add_u32 s15, s15, s9
    buffer_load_dword v251, v5, s[32:35], s15 offen
    s_add_u32 s9, s9, 131072
    s_branch L_PC_e
L_PL:
    s_load_dwordx2 s[32:33], s[0:1], 24
    s_load_dwordx2 s[44:45], s[0:1], 48
    s_load_dwordx2 s[36:37], s[0:1], 32
    s_waitcnt lgkmcnt(0)
    s_cmp_ge_u32 s4, 30
    s_cselect_b32 s64, 16, 14
    s_cselect_b32 s6, 1, 0
    s_cmp_lt_u32 s4, 14
    s_cselect_b32 s64, 0, s64
    s_cselect_b32 s6, 1, s6
    s_sub_u32 s64, s4, s64
    s_lshl_b32 s51, s64, 1
    s_add_u32 s51, s51, s6
    s_mov_b32 s46, 268435456
    s_mov_b32 s47, 0x20000
    s_mov_b32 s38, 0x40000
    s_mov_b32 s39, 0x20000
    v_lshlrev_b32 v8, 4, v0
    v_lshlrev_b32 v9, 2, v0
    v_mov_b32 v18, 155648
    v_and_b32 v27, 124, v9
    s_lshl_b32 s58, s51, 3
    s_add_u32 s58, s58, s3
    s_lshl_b32 s58, s58, 3
    s_add_u32 s58, s58, s5
    s_mul_i32 s58, s58, 1152
    s_add_u32 s58, s58, 5242880
    v_lshrrev_b32 v4, 3, v0
    v_add_u32 v4, v4, v0
    s_mul_i32 s12, s5, 1280
    v_lshl_add_u32 v29, v4, 4, s12
    s_getreg_b32 s65, hwreg(HW_REG_XCC_ID, 0, 4)
    s_lshl_b32 s65, s65, 28
    v_lshlrev_b32 v5, 1, v1
    v_lshlrev_b32 v6, 11, v2
    v_xor_b32 v5, v5, v3
    s_mul_i32 s61, s3, 917504
    s_lshl_b32 s14, s64, 7
    v_lshl_add_u32 v244, v5, 4, v6
    s_add_u32 s61, s61, s14
    v_add_u32 v245, 15360, v244
    s_mul_i32 s14, s17, 114688
    s_mul_i32 s62, s17, 7168
    v_add_u32 v246, 30720, v244
    s_add_u32 s61, s61, s14
    s_add_u32 s62, s62, 98304
    v_add_u32 v247, 46080, v244
    s_mov_b32 s34, 0x700000
    s_mov_b32 s35, 0x20000
    v_lshrrev_b32 v4, 2, v0
    v_bfe_u32 v5, v0, 3, 2
    v_and_b32 v6, 3, v0
    v_lshlrev_b32 v4, 7, v4
    v_lshl_add_u32 v4, v6, 3, v4
    v_lshl_add_u32 v4, v5, 5, v4
    v_add_u32 v10, 98304, v4
    v_xor_b32 v11, 32, v10
    v_xor_b32 v12, 64, v10
    v_xor_b32 v13, 96, v10
    v_mov_b64 v[32:33], 0
    v_mov_b64 v[34:35], 0
    v_mov_b64 v[36:37], 0
    v_mov_b64 v[38:39], 0
    v_mov_b64 v[40:41], 0
    v_mov_b64 v[42:43], 0
    v_mov_b64 v[44:45], 0
    v_mov_b64 v[46:47], 0
    s_lshl_b32 s56, s6, 2
    s_add_u32 s56, s56, s17
    s_lshl_b32 s12, s3, 3
    s_add_u32 s12, s12, s56
    s_lshl_b32 s12, s12, 7
    s_add_u32 s50, s12, 4194304
    s_mul_i32 s56, s56, 112
    s_mul_i32 s12, s3, 14
    s_add_u32 s56, s56, s12
    s_lshl_b32 s57, s56, 10
    s_lshl_b32 s59, s51, 2
    s_add_u32 s59, s59, s17
    s_lshl_b32 s59, s59, 4
    s_add_u32 s59, s59, s3
    s_mul_i32 s59, s59, 1152
    s_add_u32 s59, s59, 5242880
    v_and_b32 v4, 7, v0
    v_lshl_add_u32 v4, v1, 3, v4
    v_bfe_u32 v5, v0, 3, 1
    v_mul_u32_u24 v6, 9216, v5
    v_lshl_add_u32 v14, v4, 4, v6
    v_lshl_add_u32 v15, v4, 2, v6
    v_min_u32 v19, 52, v9
    v_mov_b32 v31, 0
    v_mov_b32 v17, 1
    s_lshl_b32 s12, s3, 2
    s_lshr_b32 s13, s4, 3
    s_add_u32 s12, s12, s13
    s_lshl_b32 s12, s12, 5
    s_and_b32 s13, s4, 7
    s_add_u32 s12, s12, s13
    s_lshl_b32 s12, s12, 2
    s_add_u32 s12, s12, 4210688
    s_cmp_eq_u32 s5, 4
    s_cselect_b32 s60, s12, s46
    s_lshl_b32 s12, s17, 1
    v_add_u32 v5, s12, v5
    v_cmp_eq_u32 s[66:67], s3, v5
    v_add_u32 v6, v4, v1
    s_mul_i32 s12, s3, 1280
    v_mov_b32 v5, s46
    v_lshl_add_u32 v28, v6, 4, s12
    v_cndmask_b32 v14, v14, v5, s[66:67]
    v_cndmask_b32 v15, v15, v5, s[66:67]
    s_mov_b32 m0, s62
    s_barrier
    ds_read_b32 v3, v18
    s_waitcnt lgkmcnt(0)
    s_branch L_Lgo2
L_XC:
    s_load_dwordx2 s[32:33], s[0:1], 24
    s_load_dwordx2 s[44:45], s[0:1], 48
    s_load_dwordx2 s[36:37], s[0:1], 32
    s_mov_b32 s46, 268435456
    s_mov_b32 s47, 0x20000
    s_mov_b32 s18, 4206592
    s_mov_b32 s22, 0x40000
    s_mov_b32 s23, 0x20000
    s_and_b32 s9, s6, 1
    s_lshl_b32 s7, s9, 17
    v_lshlrev_b32 v7, 11, v0
    s_waitcnt lgkmcnt(0)
    buffer_load_dword v22, off, s[44:47], s18 sc1
    buffer_load_dword v251, v7, s[20:23], s7 offen offset:512
    buffer_load_dword v251, v7, s[20:23], s7 offen offset:640
    buffer_load_dword v251, v7, s[20:23], s7 offen offset:768
    buffer_load_dword v251, v7, s[20:23], s7 offen offset:896
    buffer_load_dword v251, v7, s[20:23], s7 offen offset:1024
    buffer_load_dword v251, v7, s[20:23], s7 offen offset:1152
    buffer_load_dword v251, v7, s[20:23], s7 offen offset:1280
    buffer_load_dword v251, v7, s[20:23], s7 offen offset:1408
    buffer_load_dword v251, v7, s[20:23], s7 offen offset:1536
    buffer_load_dword v251, v7, s[20:23], s7 offen offset:1664
    buffer_load_dword v251, v7, s[20:23], s7 offen offset:1792
    buffer_load_dword v251, v7, s[20:23], s7 offen offset:1920
    s_mul_i32 s9, s9, 448
    s_mul_i32 s8, s3, 14
    s_add_u32 s9, s9, s8
    s_lshl_b32 s9, s9, 10
    v_lshlrev_b32 v5, 7, v0
    v_min_u32 v6, 6016, v5
    v_add_u32 v6, 8192, v6
    v_min_u32 v4, 896, v5
    s_lshl_b32 s8, s3, 10
    s_add_u32 s8, s8, 4194304
    buffer_load_dword v251, v4, s[44:47], s8 offen
    buffer_load_dword v251, v5, s[44:47], s9 offen
    buffer_load_dword v251, v6, s[44:47], s9 offen
    s_add_u32 s9, s9, 114688
    buffer_load_dword v251, v5, s[44:47], s9 offen
    buffer_load_dword v251, v6, s[44:47], s9 offen
    s_add_u32 s9, s9, 114688
    buffer_load_dword v251, v5, s[44:47], s9 offen
    buffer_load_dword v251, v6, s[44:47], s9 offen
    s_add_u32 s9, s9, 114688
    buffer_load_dword v251, v5, s[44:47], s9 offen
    buffer_load_dword v251, v6, s[44:47], s9 offen
    s_add_u32 s9, s9, 114688
L_PC_e:
    v_mov_b32 v21, 155648
    v_mov_b32 v24, 0
    v_mov_b32 v25, 0
    v_mov_b32 v26, 0
    v_mov_b32 v27, 4
    s_waitcnt vmcnt(3)
    v_add_u32 v23, 1, v22
    ds_write_b32 v21, v23
    ds_write_b128 v21, v[24:27] offset:16
    s_branch L_PC_b
L_PC_aux:
    s_load_dwordx2 s[32:33], s[0:1], 24
    s_load_dwordx2 s[44:45], s[0:1], 48
    s_load_dwordx2 s[36:37], s[0:1], 32
L_PC_b:
    s_mov_b32 s18, 4206592
    s_cmp_ge_u32 s4, 30
    s_cselect_b32 s64, 16, 14
    s_cselect_b32 s6, 1, 0
    s_cmp_lt_u32 s4, 14
    s_cselect_b32 s64, 0, s64
    s_cselect_b32 s6, 1, s6
    s_sub_u32 s64, s4, s64
    s_lshl_b32 s51, s64, 1
    s_add_u32 s51, s51, s6
    s_mov_b32 s46, 268435456
    s_mov_b32 s47, 0x20000
    s_mov_b32 s38, 0x40000
    s_mov_b32 s39, 0x20000
    v_lshlrev_b32 v8, 4, v0
    v_lshlrev_b32 v9, 2, v0
    v_mov_b32 v18, 155648
    v_and_b32 v27, 124, v9
    s_lshl_b32 s58, s51, 3
    s_add_u32 s58, s58, s3
    s_lshl_b32 s58, s58, 3
    s_add_u32 s58, s58, s5
    s_mul_i32 s58, s58, 1152
    s_add_u32 s58, s58, 5242880
    v_lshrrev_b32 v4, 3, v0
    v_add_u32 v4, v4, v0
    s_mul_i32 s12, s5, 1280
    v_lshl_add_u32 v29, v4, 4, s12
    s_getreg_b32 s65, hwreg(HW_REG_XCC_ID, 0, 4)
    s_lshl_b32 s65, s65, 28
    v_lshrrev_b32 v4, 5, v0
    s_lshl_b32 s12, s5, 1
    v_add_u32 v4, s12, v4
    v_bfe_u32 v5, v0, 4, 1
    v_bfe_u32 v6, v0, 1, 2
    v_lshl_add_u32 v5, v5, 2, v6
    v_mul_u32_u24 v5, 36, v5
    v_lshl_add_u32 v5, v4, 2, v5
    v_bfe_u32 v6, v0, 3, 1
    v_lshl_add_u32 v5, v6, 1, v5
    v_and_b32 v6, 1, v0
    v_add_lshl_u32 v30, v5, v6, 2
    v_and_b32 v6, 31, v0
    v_lshlrev_b32 v4, 11, v4
    v_lshl_add_u32 v31, v6, 2, v4
    s_lshl_b32 s14, s6, 3
    s_add_u32 s14, s14, s3
    s_lshl_b32 s14, s14, 14
    s_lshl_b32 s12, s64, 7
    s_add_u32 s14, s14, s12
    s_waitcnt lgkmcnt(0)
    s_barrier
    ds_read_b32 v3, v18
    s_lshl3_add_u32 s12, s4, s3
    s_cmp_eq_u32 s12, 240
    s_cselect_b32 s12, s5, 0
    s_cmp_eq_u32 s12, 3
    s_waitcnt lgkmcnt(0)
    v_readfirstlane_b32 s16, v3
    s_cbranch_scc0 L_go
    s_mov_b32 s12, 4210688
    s_mov_b32 s13, 0
    v_lshrrev_b32 v4, 1, v0
    v_and_b32 v5, 1, v0
    v_lshlrev_b32 v4, 7, v4
    v_lshl_add_u32 v6, v5, 4, v4
L_EP_go:
    s_sleep 4
    ds_read_b32 v4, v18 offset:20
    s_waitcnt lgkmcnt(0)
    v_cmp_gt_u32 vcc, 4, v4
    s_cbranch_vccnz L_EP_go
L_EP_loop:
    buffer_load_dwordx4 v[20:23], v6, s[44:47], s12 offen sc1
    s_add_u32 s13, s13, 1
    s_cmp_gt_u32 s13, 65536
    s_cbranch_scc1 L_fin
    s_waitcnt vmcnt(0)
    v_xor_b32 v20, s16, v20
    v_xor_b32 v21, s16, v21
    v_xor_b32 v22, s16, v22
    v_xor_b32 v23, s16, v23
    v_or3_b32 v20, v20, v21, v22
    v_or_b32 v20, v20, v23
    v_lshlrev_b32 v20, 4, v20
    v_cmp_ne_u32 vcc, 0, v20
    s_cbranch_vccnz L_EP_loop
    buffer_store_dword v3, off, s[44:47], s18 sc1
    s_branch L_fin
L_QC:
    s_load_dwordx2 s[32:33], s[0:1], 24
    s_load_dwordx2 s[44:45], s[0:1], 48
    s_load_dwordx2 s[36:37], s[0:1], 32
    v_lshrrev_b32 v1, 4, v0
    v_and_b32 v2, 15, v0
    s_and_b32 s8, s5, 1
    s_lshr_b32 s9, s5, 1
    s_and_b32 s6, s4, 1
    s_lshr_b32 s7, s4, 1
    s_lshl_b32 s10, s6, 1
    s_add_u32 s10, s10, s8
    s_lshl_b32 s14, s7, 1
    s_add_u32 s14, s14, s9
    s_lshl_b32 s15, s3, 2
    s_add_u32 s15, s15, s10
    s_lshl_b32 s15, s15, 6
    s_add_u32 s15, s15, s14
    s_lshl_b32 s15, s15, 2
    s_add_u32 s50, s15, 4194304
    s_mul_i32 s10, s10, 224
    s_mul_i32 s11, s3, 14
    s_add_u32 s10, s10, s11
    s_add_u32 s10, s10, s14
    s_lshl_b32 s62, s10, 10
    s_add_u32 s63, s62, 114688
    s_lshl_b32 s60, s10, 8
    s_add_u32 s60, s60, 2097152
    s_add_u32 s61, s60, 28672
    v_and_b32 v19, 32, v0
    v_lshlrev_b32 v19, 2, v19
    v_mov_b64 v[32:33], 0
    v_mov_b64 v[34:35], 0
    v_mov_b64 v[36:37], 0
    v_mov_b64 v[38:39], 0
    v_mov_b64 v[40:41], 0
    v_mov_b64 v[42:43], 0
    v_mov_b64 v[44:45], 0
    v_mov_b64 v[46:47], 0
    v_mov_b64 v[48:49], 0
    v_mov_b64 v[50:51], 0
    v_mov_b64 v[52:53], 0
    v_mov_b64 v[54:55], 0
    v_mov_b64 v[56:57], 0
    v_mov_b64 v[58:59], 0
    v_mov_b64 v[60:61], 0
    v_mov_b64 v[62:63], 0
    v_mov_b64 v[136:137], 0
    v_mov_b64 v[138:139], 0
    v_mov_b64 v[140:141], 0
    v_mov_b64 v[142:143], 0
    v_mov_b64 v[144:145], 0
    v_mov_b64 v[146:147], 0
    v_mov_b64 v[148:149], 0
    v_mov_b64 v[150:151], 0
    v_mov_b64 v[152:153], 0
    v_mov_b64 v[154:155], 0
    v_mov_b64 v[156:157], 0
    v_mov_b64 v[158:159], 0
    v_bfe_u32 v4, v0, 2, 2
    v_and_b32 v5, 1, v1
    v_lshl_add_u32 v6, v5, 3, v4
    v_lshlrev_b32 v6, 7, v6
    v_lshrrev_b32 v7, 1, v1
    v_lshl_add_u32 v6, v7, 12, v6
    v_and_b32 v7, 3, v0
    v_lshl_add_u32 v6, v7, 3, v6
    v_lshrrev_b32 v4, 1, v4
    v_lshl_add_u32 v4, v5, 1, v4
    s_lshl_b32 s11, s9, 1
    v_xor_b32 v4, s11, v4
    v_lshl_add_u32 v232, v4, 5, v6
    v_xor_b32 v233, 32, v232
    v_lshrrev_b32 v4, 1, v2
    v_xor_b32 v4, v4, v1
    s_lshl_b32 s11, s8, 12
    s_add_u32 s11, s11, 16384
    v_lshl_add_u32 v5, v2, 7, s11
    v_lshl_add_u32 v234, v4, 4, v5
    v_xor_b32 v235, 64, v234
    v_add_u32 v236, 49152, v232
    v_add_u32 v237, 49152, v233
    v_add_u32 v238, 49152, v234
    v_add_u32 v239, 49152, v235
    s_mov_b32 s52, 0xbdd2d3e8
    s_mov_b32 s53, 0xbdd2d3e8
    v_mov_b32 v26, 1
    v_mov_b32 v242, 0xc0135761
    v_mov_b32 v243, 0xc0135761
    s_mov_b32 s46, 268435456
    s_mov_b32 s47, 0x20000
    v_lshlrev_b32 v8, 4, v0
    v_mov_b32 v18, 155648
    s_getreg_b32 s68, hwreg(HW_REG_XCC_ID, 0, 4)
    s_lshl_b32 s68, s68, 28
    ds_write_b128 v18, v[32:35] offset:16
    s_mov_b32 s13, 4
    s_mov_b32 s18, 4206592
    s_waitcnt lgkmcnt(0)
    buffer_load_dword v22, off, s[44:47], s18 sc1
.p2align 6
L_QC_loop:
    s_barrier
    v_mfma_f32_16x16x32_bf16 v[32:35], v[136:139], v[152:155], v[32:35]
    ds_read_b128 v[80:83], v234 offset:0
    ds_read_b64_tr_b16 v[64:65], v232 offset:0
    v_mfma_f32_16x16x32_bf16 v[36:39], v[140:143], v[152:155], v[36:39]
    ds_read_b64_tr_b16 v[66:67], v232 offset:512
    ds_read_b64_tr_b16 v[68:69], v233 offset:0
    v_mfma_f32_16x16x32_bf16 v[40:43], v[144:147], v[152:155], v[40:43]
    ds_read_b64_tr_b16 v[70:71], v233 offset:512
    ds_read_b64_tr_b16 v[72:73], v232 offset:2048
    v_mfma_f32_16x16x32_bf16 v[44:47], v[148:151], v[152:155], v[44:47]
    ds_read_b64_tr_b16 v[74:75], v232 offset:2560
    ds_read_b64_tr_b16 v[76:77], v233 offset:2048
    v_mfma_f32_16x16x32_bf16 v[48:51], v[136:139], v[156:159], v[48:51]
    ds_read_b64_tr_b16 v[78:79], v233 offset:2560
    ds_read_b128 v[84:87], v234 offset:2048
    v_mfma_f32_16x16x32_bf16 v[52:55], v[140:143], v[156:159], v[52:55]
    ds_read_b128 v[104:107], v235 offset:0
    ds_read_b64_tr_b16 v[88:89], v232 offset:8192
    v_mfma_f32_16x16x32_bf16 v[56:59], v[144:147], v[156:159], v[56:59]
    ds_read_b64_tr_b16 v[90:91], v232 offset:8704
    ds_read_b64_tr_b16 v[92:93], v233 offset:8192
    v_mfma_f32_16x16x32_bf16 v[60:63], v[148:151], v[156:159], v[60:63]
    s_waitcnt lgkmcnt(11)
    ds_read_b64_tr_b16 v[94:95], v233 offset:8704
    ds_read_b64_tr_b16 v[96:97], v232 offset:10240
    s_waitcnt lgkmcnt(11)
    v_mfma_f32_16x16x32_bf16 v[32:35], v[64:67], v[80:83], v[32:35]
    ds_read_b64_tr_b16 v[98:99], v232 offset:10752
    ds_read_b64_tr_b16 v[100:101], v233 offset:10240
    v_mfma_f32_16x16x32_bf16 v[36:39], v[68:71], v[80:83], v[36:39]
    ds_read_b64_tr_b16 v[102:103], v233 offset:10752
    ds_read_b128 v[108:111], v235 offset:2048
    s_waitcnt lgkmcnt(10)
    v_mfma_f32_16x16x32_bf16 v[40:43], v[72:75], v[80:83], v[40:43]
    v_mfma_f32_16x16x32_bf16 v[44:47], v[76:79], v[80:83], v[44:47]
    v_mfma_f32_16x16x32_bf16 v[48:51], v[64:67], v[84:87], v[48:51]
    v_mfma_f32_16x16x32_bf16 v[52:55], v[68:71], v[84:87], v[52:55]
    v_mfma_f32_16x16x32_bf16 v[56:59], v[72:75], v[84:87], v[56:59]
    v_mfma_f32_16x16x32_bf16 v[60:63], v[76:79], v[84:87], v[60:63]
    s_waitcnt lgkmcnt(0)
    s_barrier
    v_mfma_f32_16x16x32_bf16 v[32:35], v[88:91], v[104:107], v[32:35]
    ds_read_b128 v[128:131], v234 offset:24576
    ds_read_b64_tr_b16 v[112:113], v232 offset:24576
    v_mfma_f32_16x16x32_bf16 v[36:39], v[92:95], v[104:107], v[36:39]
    ds_read_b64_tr_b16 v[114:115], v232 offset:25088
    ds_read_b64_tr_b16 v[116:117], v233 offset:24576
    v_mfma_f32_16x16x32_bf16 v[40:43], v[96:99], v[104:107], v[40:43]
    ds_read_b64_tr_b16 v[118:119], v233 offset:25088
    ds_read_b64_tr_b16 v[120:121], v232 offset:26624
    v_mfma_f32_16x16x32_bf16 v[44:47], v[100:103], v[104:107], v[44:47]
    ds_read_b64_tr_b16 v[122:123], v232 offset:27136
    ds_read_b64_tr_b16 v[124:125], v233 offset:26624
    v_mfma_f32_16x16x32_bf16 v[48:51], v[88:91], v[108:111], v[48:51]
    ds_read_b64_tr_b16 v[126:127], v233 offset:27136
    ds_read_b128 v[132:135], v234 offset:26624
    v_mfma_f32_16x16x32_bf16 v[52:55], v[92:95], v[108:111], v[52:55]
    ds_read_b128 v[152:155], v235 offset:24576
    ds_read_b64_tr_b16 v[136:137], v232 offset:32768
    v_mfma_f32_16x16x32_bf16 v[56:59], v[96:99], v[108:111], v[56:59]
    ds_read_b64_tr_b16 v[138:139], v232 offset:33280
    ds_read_b64_tr_b16 v[140:141], v233 offset:32768
    v_mfma_f32_16x16x32_bf16 v[60:63], v[100:103], v[108:111], v[60:63]
    s_waitcnt lgkmcnt(11)
    ds_read_b64_tr_b16 v[142:143], v233 offset:33280
    ds_read_b64_tr_b16 v[144:145], v232 offset:34816
    s_waitcnt lgkmcnt(11)
    v_mfma_f32_16x16x32_bf16 v[32:35], v[112:115], v[128:131], v[32:35]
    ds_read_b64_tr_b16 v[146:147], v232 offset:35328
    ds_read_b64_tr_b16 v[148:149], v233 offset:34816
    v_mfma_f32_16x16x32_bf16 v[36:39], v[116:119], v[128:131], v[36:39]
    ds_read_b64_tr_b16 v[150:151], v233 offset:35328
    ds_read_b128 v[156:159], v235 offset:26624
    s_waitcnt lgkmcnt(10)
    v_mfma_f32_16x16x32_bf16 v[40:43], v[120:123], v[128:131], v[40:43]
    v_mfma_f32_16x16x32_bf16 v[44:47], v[124:127], v[128:131], v[44:47]
    v_mfma_f32_16x16x32_bf16 v[48:51], v[112:115], v[132:135], v[48:51]
    v_mfma_f32_16x16x32_bf16 v[52:55], v[116:119], v[132:135], v[52:55]
    v_mfma_f32_16x16x32_bf16 v[56:59], v[120:123], v[132:135], v[56:59]
    v_mfma_f32_16x16x32_bf16 v[60:63], v[124:127], v[132:135], v[60:63]
    s_waitcnt lgkmcnt(0)
    s_barrier
    v_mfma_f32_16x16x32_bf16 v[32:35], v[136:139], v[152:155], v[32:35]
    ds_read_b128 v[80:83], v238 offset:0
    ds_read_b64_tr_b16 v[64:65], v236 offset:0
    v_mfma_f32_16x16x32_bf16 v[36:39], v[140:143], v[152:155], v[36:39]
    ds_read_b64_tr_b16 v[66:67], v236 offset:512
    ds_read_b64_tr_b16 v[68:69], v237 offset:0
    v_mfma_f32_16x16x32_bf16 v[40:43], v[144:147], v[152:155], v[40:43]
    ds_read_b64_tr_b16 v[70:71], v237 offset:512
    ds_read_b64_tr_b16 v[72:73], v236 offset:2048
    v_mfma_f32_16x16x32_bf16 v[44:47], v[148:151], v[152:155], v[44:47]
    ds_read_b64_tr_b16 v[74:75], v236 offset:2560
    ds_read_b64_tr_b16 v[76:77], v237 offset:2048
    v_mfma_f32_16x16x32_bf16 v[48:51], v[136:139], v[156:159], v[48:51]
    ds_read_b64_tr_b16 v[78:79], v237 offset:2560
    ds_read_b128 v[84:87], v238 offset:2048
    v_mfma_f32_16x16x32_bf16 v[52:55], v[140:143], v[156:159], v[52:55]
    ds_read_b128 v[104:107], v239 offset:0
    ds_read_b64_tr_b16 v[88:89], v236 offset:8192
    v_mfma_f32_16x16x32_bf16 v[56:59], v[144:147], v[156:159], v[56:59]
    ds_read_b64_tr_b16 v[90:91], v236 offset:8704
    ds_read_b64_tr_b16 v[92:93], v237 offset:8192
    v_mfma_f32_16x16x32_bf16 v[60:63], v[148:151], v[156:159], v[60:63]
    s_waitcnt lgkmcnt(11)
    ds_read_b64_tr_b16 v[94:95], v237 offset:8704
    ds_read_b64_tr_b16 v[96:97], v236 offset:10240
    s_waitcnt lgkmcnt(11)
    v_mfma_f32_16x16x32_bf16 v[32:35], v[64:67], v[80:83], v[32:35]
    ds_read_b64_tr_b16 v[98:99], v236 offset:10752
    ds_read_b64_tr_b16 v[100:101], v237 offset:10240
    v_mfma_f32_16x16x32_bf16 v[36:39], v[68:71], v[80:83], v[36:39]
    ds_read_b64_tr_b16 v[102:103], v237 offset:10752
    ds_read_b128 v[108:111], v239 offset:2048
    s_waitcnt lgkmcnt(10)
    v_mfma_f32_16x16x32_bf16 v[40:43], v[72:75], v[80:83], v[40:43]
    s_waitcnt vmcnt(0)
    v_mfma_f32_16x16x32_bf16 v[44:47], v[76:79], v[80:83], v[44:47]
    v_mfma_f32_16x16x32_bf16 v[48:51], v[64:67], v[84:87], v[48:51]
    v_mfma_f32_16x16x32_bf16 v[52:55], v[68:71], v[84:87], v[52:55]
    v_mfma_f32_16x16x32_bf16 v[56:59], v[72:75], v[84:87], v[56:59]
    v_mfma_f32_16x16x32_bf16 v[60:63], v[76:79], v[84:87], v[60:63]
    s_waitcnt lgkmcnt(0)
    s_barrier
    v_mfma_f32_16x16x32_bf16 v[32:35], v[88:91], v[104:107], v[32:35]
    ds_read_b128 v[128:131], v238 offset:24576
    ds_read_b64_tr_b16 v[112:113], v236 offset:24576
    v_mfma_f32_16x16x32_bf16 v[36:39], v[92:95], v[104:107], v[36:39]
    ds_read_b64_tr_b16 v[114:115], v236 offset:25088
    ds_read_b64_tr_b16 v[116:117], v237 offset:24576
    v_mfma_f32_16x16x32_bf16 v[40:43], v[96:99], v[104:107], v[40:43]
    ds_read_b64_tr_b16 v[118:119], v237 offset:25088
    ds_read_b64_tr_b16 v[120:121], v236 offset:26624
    v_mfma_f32_16x16x32_bf16 v[44:47], v[100:103], v[104:107], v[44:47]
    ds_read_b64_tr_b16 v[122:123], v236 offset:27136
    ds_read_b64_tr_b16 v[124:125], v237 offset:26624
    v_mfma_f32_16x16x32_bf16 v[48:51], v[88:91], v[108:111], v[48:51]
    ds_read_b64_tr_b16 v[126:127], v237 offset:27136
    ds_read_b128 v[132:135], v238 offset:26624
    v_mfma_f32_16x16x32_bf16 v[52:55], v[92:95], v[108:111], v[52:55]
    ds_read_b128 v[152:155], v239 offset:24576
    ds_read_b64_tr_b16 v[136:137], v236 offset:32768
    v_mfma_f32_16x16x32_bf16 v[56:59], v[96:99], v[108:111], v[56:59]
    ds_read_b64_tr_b16 v[138:139], v236 offset:33280
    ds_read_b64_tr_b16 v[140:141], v237 offset:32768
    v_mfma_f32_16x16x32_bf16 v[60:63], v[100:103], v[108:111], v[60:63]
    s_waitcnt lgkmcnt(11)
    ds_read_b64_tr_b16 v[142:143], v237 offset:33280
    ds_read_b64_tr_b16 v[144:145], v236 offset:34816
    s_waitcnt lgkmcnt(11)
    v_mfma_f32_16x16x32_bf16 v[32:35], v[112:115], v[128:131], v[32:35]
    ds_read_b64_tr_b16 v[146:147], v236 offset:35328
    ds_read_b64_tr_b16 v[148:149], v237 offset:34816
    v_mfma_f32_16x16x32_bf16 v[36:39], v[116:119], v[128:131], v[36:39]
    ds_read_b64_tr_b16 v[150:151], v237 offset:35328
    ds_read_b128 v[156:159], v239 offset:26624
    s_waitcnt lgkmcnt(10)
    v_mfma_f32_16x16x32_bf16 v[40:43], v[120:123], v[128:131], v[40:43]
    s_sub_u32 s13, s13, 1
    s_cmp_lg_u32 s13, 0
    v_mfma_f32_16x16x32_bf16 v[44:47], v[124:127], v[128:131], v[44:47]
    v_mfma_f32_16x16x32_bf16 v[48:51], v[112:115], v[132:135], v[48:51]
    v_mfma_f32_16x16x32_bf16 v[52:55], v[116:119], v[132:135], v[52:55]
    v_mfma_f32_16x16x32_bf16 v[56:59], v[120:123], v[132:135], v[56:59]
    v_mfma_f32_16x16x32_bf16 v[60:63], v[124:127], v[132:135], v[60:63]
    s_waitcnt lgkmcnt(0)
    s_cbranch_scc1 L_QC_loop
    v_add_u32 v3, 1, v22
    v_mfma_f32_16x16x32_bf16 v[32:35], v[136:139], v[152:155], v[32:35]
    v_mfma_f32_16x16x32_bf16 v[36:39], v[140:143], v[152:155], v[36:39]
    v_mfma_f32_16x16x32_bf16 v[40:43], v[144:147], v[152:155], v[40:43]
    v_mfma_f32_16x16x32_bf16 v[44:47], v[148:151], v[152:155], v[44:47]
    v_mfma_f32_16x16x32_bf16 v[48:51], v[136:139], v[156:159], v[48:51]
    v_mfma_f32_16x16x32_bf16 v[52:55], v[140:143], v[156:159], v[52:55]
    v_mfma_f32_16x16x32_bf16 v[56:59], v[144:147], v[156:159], v[56:59]
    v_mfma_f32_16x16x32_bf16 v[60:63], v[148:151], v[156:159], v[60:63]
    v_readfirstlane_b32 s16, v3
    s_nop 3
    v_pk_mul_f32 v[160:161], v[32:33], v[32:33]
    v_pk_mul_f32 v[162:163], v[34:35], v[34:35]
    v_pk_mul_f32 v[164:165], v[36:37], v[36:37]
    v_pk_mul_f32 v[166:167], v[38:39], v[38:39]
    v_pk_fma_f32 v[160:161], v[160:161], s[52:53], v[242:243]
    v_pk_fma_f32 v[162:163], v[162:163], s[52:53], v[242:243]
    v_pk_fma_f32 v[164:165], v[164:165], s[52:53], v[242:243]
    v_pk_fma_f32 v[166:167], v[166:167], s[52:53], v[242:243]
    v_pk_mul_f32 v[160:161], v[160:161], v[32:33]
    v_pk_mul_f32 v[162:163], v[162:163], v[34:35]
    v_pk_mul_f32 v[164:165], v[164:165], v[36:37]
    v_pk_mul_f32 v[166:167], v[166:167], v[38:39]
    s_add_u32 s68, s68, s16
    v_exp_f32 v160, v160
    v_exp_f32 v161, v161
    v_exp_f32 v162, v162
    v_exp_f32 v163, v163
    v_exp_f32 v164, v164
    v_exp_f32 v165, v165
    v_exp_f32 v166, v166
    v_exp_f32 v167, v167
    v_pk_add_f32 v[160:161], v[160:161], 1.0 op_sel_hi:[1,0]
    v_pk_add_f32 v[162:163], v[162:163], 1.0 op_sel_hi:[1,0]
    v_pk_add_f32 v[164:165], v[164:165], 1.0 op_sel_hi:[1,0]
    v_pk_add_f32 v[166:167], v[166:167], 1.0 op_sel_hi:[1,0]
    v_rcp_f32 v160, v160
    v_rcp_f32 v161, v161
    v_rcp_f32 v162, v162
    v_rcp_f32 v163, v163
    v_rcp_f32 v164, v164
    v_rcp_f32 v165, v165
    v_rcp_f32 v166, v166
    v_rcp_f32 v167, v167
    v_mov_b32 v4, s68
    v_pk_mul_f32 v[160:161], v[160:161], v[32:33]
    v_pk_mul_f32 v[162:163], v[162:163], v[34:35]
    v_pk_mul_f32 v[164:165], v[164:165], v[36:37]
    v_pk_mul_f32 v[166:167], v[166:167], v[38:39]
    v_pk_mul_f32 v[160:161], v[160:161], v[40:41]
    v_pk_mul_f32 v[162:163], v[162:163], v[42:43]
    v_pk_mul_f32 v[164:165], v[164:165], v[44:45]
    v_pk_mul_f32 v[166:167], v[166:167], v[46:47]
    v_cvt_pk_bf16_f32 v248, v160, v161
    v_cvt_pk_bf16_f32 v249, v162, v163
    v_cvt_pk_bf16_f32 v250, v164, v165
    v_cvt_pk_bf16_f32 v251, v166, v167
    buffer_store_dwordx4 v[248:251], v8, s[44:47], s62 offen
    v_pk_mul_f32 v[160:161], v[48:49], v[48:49]
    v_pk_mul_f32 v[162:163], v[50:51], v[50:51]
    v_pk_mul_f32 v[164:165], v[52:53], v[52:53]
    v_pk_mul_f32 v[166:167], v[54:55], v[54:55]
    v_pk_fma_f32 v[160:161], v[160:161], s[52:53], v[242:243]
    v_pk_fma_f32 v[162:163], v[162:163], s[52:53], v[242:243]
    v_pk_fma_f32 v[164:165], v[164:165], s[52:53], v[242:243]
    v_pk_fma_f32 v[166:167], v[166:167], s[52:53], v[242:243]
    v_pk_mul_f32 v[160:161], v[160:161], v[48:49]
    v_pk_mul_f32 v[162:163], v[162:163], v[50:51]
    v_pk_mul_f32 v[164:165], v[164:165], v[52:53]
    v_pk_mul_f32 v[166:167], v[166:167], v[54:55]
    v_exp_f32 v160, v160
    v_exp_f32 v161, v161
    v_exp_f32 v162, v162
    v_exp_f32 v163, v163
    v_exp_f32 v164, v164
    v_exp_f32 v165, v165
    v_exp_f32 v166, v166
    v_exp_f32 v167, v167
    v_pk_add_f32 v[160:161], v[160:161], 1.0 op_sel_hi:[1,0]
    v_pk_add_f32 v[162:163], v[162:163], 1.0 op_sel_hi:[1,0]
    v_pk_add_f32 v[164:165], v[164:165], 1.0 op_sel_hi:[1,0]
    v_pk_add_f32 v[166:167], v[166:167], 1.0 op_sel_hi:[1,0]
    v_rcp_f32 v160, v160
    v_rcp_f32 v161, v161
    v_rcp_f32 v162, v162
    v_rcp_f32 v163, v163
    v_rcp_f32 v164, v164
    v_rcp_f32 v165, v165
    v_rcp_f32 v166, v166
    v_rcp_f32 v167, v167
    s_nop 0
    v_pk_mul_f32 v[160:161], v[160:161], v[48:49]
    v_pk_mul_f32 v[162:163], v[162:163], v[50:51]
    v_pk_mul_f32 v[164:165], v[164:165], v[52:53]
    v_pk_mul_f32 v[166:167], v[166:167], v[54:55]
    v_pk_mul_f32 v[160:161], v[160:161], v[56:57]
    v_pk_mul_f32 v[162:163], v[162:163], v[58:59]
    v_pk_mul_f32 v[164:165], v[164:165], v[60:61]
    v_pk_mul_f32 v[166:167], v[166:167], v[62:63]
    v_cvt_pk_bf16_f32 v252, v160, v161
    v_cvt_pk_bf16_f32 v253, v162, v163
    v_cvt_pk_bf16_f32 v254, v164, v165
    v_cvt_pk_bf16_f32 v255, v166, v167
    buffer_store_dwordx4 v[252:255], v8, s[44:47], s63 offen
    s_waitcnt vmcnt(0)
    buffer_store_dword v4, v19, s[44:47], s50 offen
    s_mov_b64 exec, 1
    ds_add_u32 v18, v26 offset:28
    s_mov_b64 exec, -1
    s_nop 0
    s_cmp_ge_u32 s4, 30
    s_cselect_b32 s64, 16, 14
    s_cselect_b32 s6, 1, 0
    s_cmp_lt_u32 s4, 14
    s_cselect_b32 s64, 0, s64
    s_cselect_b32 s6, 1, s6
    s_sub_u32 s64, s4, s64
    s_lshl_b32 s51, s64, 1
    s_add_u32 s51, s51, s6
    s_mov_b32 s46, 268435456
    s_mov_b32 s47, 0x20000
    s_mov_b32 s38, 0x40000
    s_mov_b32 s39, 0x20000
    v_lshlrev_b32 v8, 4, v0
    v_lshlrev_b32 v9, 2, v0
    v_mov_b32 v18, 155648
    v_and_b32 v27, 124, v9
    s_lshl_b32 s58, s51, 3
    s_add_u32 s58, s58, s3
    s_lshl_b32 s58, s58, 3
    s_add_u32 s58, s58, s5
    s_mul_i32 s58, s58, 1152
    s_add_u32 s58, s58, 5242880
    v_lshrrev_b32 v4, 3, v0
    v_add_u32 v4, v4, v0
    s_mul_i32 s12, s5, 1280
    v_lshl_add_u32 v29, v4, 4, s12
    s_getreg_b32 s65, hwreg(HW_REG_XCC_ID, 0, 4)
    s_lshl_b32 s65, s65, 28
    v_lshrrev_b32 v4, 5, v0
    s_lshl_b32 s12, s5, 1
    v_add_u32 v4, s12, v4
    v_bfe_u32 v5, v0, 4, 1
    v_bfe_u32 v6, v0, 1, 2
    v_lshl_add_u32 v5, v5, 2, v6
    v_mul_u32_u24 v5, 36, v5
    v_lshl_add_u32 v5, v4, 2, v5
    v_bfe_u32 v6, v0, 3, 1
    v_lshl_add_u32 v5, v6, 1, v5
    v_and_b32 v6, 1, v0
    v_add_lshl_u32 v30, v5, v6, 2
    v_and_b32 v6, 31, v0
    v_lshlrev_b32 v4, 11, v4
    v_lshl_add_u32 v31, v6, 2, v4
    s_lshl_b32 s14, s6, 3
    s_add_u32 s14, s14, s3
    s_lshl_b32 s14, s14, 14
    s_lshl_b32 s12, s64, 7
    s_add_u32 s14, s14, s12
    s_lshl_b32 s12, s3, 9
    s_add_u32 s12, s12, 4210688
    v_and_b32 v5, 7, v0
    v_bfe_u32 v6, v0, 3, 2
    v_lshlrev_b32 v5, 2, v5
    v_lshl_add_u32 v5, v6, 7, v5
L_goq:
    s_sleep 1
    ds_read_b32 v4, v18 offset:20
    s_waitcnt lgkmcnt(0)
    v_cmp_gt_u32 vcc, 4, v4
    s_cbranch_vccnz L_goq
    buffer_load_dword v6, v5, s[44:47], s12 offen sc1
    s_cmp_eq_u32 s5, s3
    s_cselect_b32 s12, s46, s58
    s_mov_b32 s13, 0
    buffer_load_dwordx4 v[20:23], v8, s[44:47], s12 offen sc1
    buffer_load_dword v24, v27, s[44:47], s12 offen offset:1024 sc1
    s_waitcnt vmcnt(0)
    v_cmp_ne_u32 vcc, s68, v6
    s_cbranch_vccnz L_pubB
L_pubB_ret:
    s_cbranch_scc1 L_fin_bar
    s_branch L_fin_chk
L_pubB:
    v_bitop3_b32 v16, v248, v249, s16 bitop3:0x96
    v_bitop3_b32 v17, v252, v253, s16 bitop3:0x96
    s_add_u32 s62, s62, 1048576
    s_add_u32 s63, s63, 1048576
    v_bitop3_b32 v16, v16, v250, v251 bitop3:0x96
    v_bitop3_b32 v17, v17, v254, v255 bitop3:0x96
    buffer_store_dwordx4 v[248:251], v8, s[44:47], s62 offen sc1
    buffer_store_dword v16, v9, s[44:47], s60 offen sc1
    buffer_store_dwordx4 v[252:255], v8, s[44:47], s63 offen sc1
    buffer_store_dword v17, v9, s[44:47], s61 offen sc1
    s_cmp_eq_u32 s5, s3
    s_branch L_pubB_ret
L_go:
    s_sleep 1
    ds_read_b32 v4, v18 offset:20
    s_waitcnt lgkmcnt(0)
    v_cmp_gt_u32 vcc, 4, v4
    s_cbranch_vccnz L_go
    s_branch L_fin
L_slow:
    s_waitcnt vmcnt(0)
    v_mov_b32 v4, 4
    s_mov_b64 exec, 1
    ds_add_u32 v18, v4 offset:20
    s_mov_b64 exec, -1
    s_lshl_b32 s56, s56, 8
    s_add_u32 s56, s56, 2097152
    s_mov_b32 s13, 0
L_slow_loop:
    buffer_load_dword v6, v19, s[44:47], s50 offen sc1
    s_sub_u32 s12, s56, 2097152
    s_lshl_b32 s12, s12, 2
    s_add_u32 s12, s12, 1048576
    buffer_load_dwordx4 v[176:179], v8, s[44:47], s12 offen offset:0 sc1
    buffer_load_dword v232, v9, s[44:47], s56 offen offset:0 sc1
    buffer_load_dwordx4 v[180:183], v8, s[44:47], s12 offen offset:1024 sc1
    buffer_load_dword v233, v9, s[44:47], s56 offen offset:256 sc1
    buffer_load_dwordx4 v[184:187], v8, s[44:47], s12 offen offset:2048 sc1
    buffer_load_dword v234, v9, s[44:47], s56 offen offset:512 sc1
    buffer_load_dwordx4 v[188:191], v8, s[44:47], s12 offen offset:3072 sc1
    buffer_load_dword v235, v9, s[44:47], s56 offen offset:768 sc1
    s_add_u32 s12, s12, 4096
    buffer_load_dwordx4 v[192:195], v8, s[44:47], s12 offen offset:0 sc1
    buffer_load_dword v236, v9, s[44:47], s56 offen offset:1024 sc1
    buffer_load_dwordx4 v[196:199], v8, s[44:47], s12 offen offset:1024 sc1
    buffer_load_dword v237, v9, s[44:47], s56 offen offset:1280 sc1
    buffer_load_dwordx4 v[200:203], v8, s[44:47], s12 offen offset:2048 sc1
    buffer_load_dword v238, v9, s[44:47], s56 offen offset:1536 sc1
    buffer_load_dwordx4 v[204:207], v8, s[44:47], s12 offen offset:3072 sc1
    buffer_load_dword v239, v9, s[44:47], s56 offen offset:1792 sc1
    s_add_u32 s12, s12, 4096
    buffer_load_dwordx4 v[208:211], v8, s[44:47], s12 offen offset:0 sc1
    buffer_load_dword v240, v9, s[44:47], s56 offen offset:2048 sc1
    buffer_load_dwordx4 v[212:215], v8, s[44:47], s12 offen offset:1024 sc1
    buffer_load_dword v241, v9, s[44:47], s56 offen offset:2304 sc1
    buffer_load_dwordx4 v[216:219], v8, s[44:47], s12 offen offset:2048 sc1
    buffer_load_dword v242, v9, s[44:47], s56 offen offset:2560 sc1
    buffer_load_dwordx4 v[220:223], v8, s[44:47], s12 offen offset:3072 sc1
    buffer_load_dword v243, v9, s[44:47], s56 offen offset:2816 sc1
    s_add_u32 s12, s12, 4096
    buffer_load_dwordx4 v[224:227], v8, s[44:47], s12 offen offset:0 sc1
    buffer_load_dword v244, v9, s[44:47], s56 offen offset:3072 sc1
    buffer_load_dwordx4 v[228:231], v8, s[44:47], s12 offen offset:1024 sc1
    buffer_load_dword v245, v9, s[44:47], s56 offen offset:3328 sc1
    s_add_u32 s13, s13, 1
    s_waitcnt vmcnt(0)
    v_mov_b32 v5, 0
    v_bitop3_b32 v4, v176, v177, v232 bitop3:0x96
    v_bitop3_b32 v4, v4, v178, v179 bitop3:0x96
    v_bitop3_b32 v5, v4, s16, v5 bitop3:0xbe
    v_bitop3_b32 v4, v180, v181, v233 bitop3:0x96
    v_bitop3_b32 v4, v4, v182, v183 bitop3:0x96
    v_bitop3_b32 v5, v4, s16, v5 bitop3:0xbe
    v_bitop3_b32 v4, v184, v185, v234 bitop3:0x96
    v_bitop3_b32 v4, v4, v186, v187 bitop3:0x96
    v_bitop3_b32 v5, v4, s16, v5 bitop3:0xbe
    v_bitop3_b32 v4, v188, v189, v235 bitop3:0x96
    v_bitop3_b32 v4, v4, v190, v191 bitop3:0x96
    v_bitop3_b32 v5, v4, s16, v5 bitop3:0xbe
    v_bitop3_b32 v4, v192, v193, v236 bitop3:0x96
    v_bitop3_b32 v4, v4, v194, v195 bitop3:0x96
    v_bitop3_b32 v5, v4, s16, v5 bitop3:0xbe
    v_bitop3_b32 v4, v196, v197, v237 bitop3:0x96
    v_bitop3_b32 v4, v4, v198, v199 bitop3:0x96
    v_bitop3_b32 v5, v4, s16, v5 bitop3:0xbe
    v_bitop3_b32 v4, v200, v201, v238 bitop3:0x96
    v_bitop3_b32 v4, v4, v202, v203 bitop3:0x96
    v_bitop3_b32 v5, v4, s16, v5 bitop3:0xbe
    v_bitop3_b32 v4, v204, v205, v239 bitop3:0x96
    v_bitop3_b32 v4, v4, v206, v207 bitop3:0x96
    v_bitop3_b32 v5, v4, s16, v5 bitop3:0xbe
    v_bitop3_b32 v4, v208, v209, v240 bitop3:0x96
    v_bitop3_b32 v4, v4, v210, v211 bitop3:0x96
    v_bitop3_b32 v5, v4, s16, v5 bitop3:0xbe
    v_bitop3_b32 v4, v212, v213, v241 bitop3:0x96
    v_bitop3_b32 v4, v4, v214, v215 bitop3:0x96
    v_bitop3_b32 v5, v4, s16, v5 bitop3:0xbe
    v_bitop3_b32 v4, v216, v217, v242 bitop3:0x96
    v_bitop3_b32 v4, v4, v218, v219 bitop3:0x96
    v_bitop3_b32 v5, v4, s16, v5 bitop3:0xbe
    v_bitop3_b32 v4, v220, v221, v243 bitop3:0x96
    v_bitop3_b32 v4, v4, v222, v223 bitop3:0x96
    v_bitop3_b32 v5, v4, s16, v5 bitop3:0xbe
    v_bitop3_b32 v4, v224, v225, v244 bitop3:0x96
    v_bitop3_b32 v4, v4, v226, v227 bitop3:0x96
    v_bitop3_b32 v5, v4, s16, v5 bitop3:0xbe
    v_bitop3_b32 v4, v228, v229, v245 bitop3:0x96
    v_bitop3_b32 v4, v4, v230, v231 bitop3:0x96
    v_bitop3_b32 v5, v4, s16, v5 bitop3:0xbe
    v_cmp_ne_u32 vcc, s65, v6
    s_cbranch_vccz L_flag_done
    v_cmp_ne_u32 vcc, 0, v5
    s_cmp_gt_u32 s13, 65536
    s_cbranch_scc1 L_flag_done
    s_cbranch_vccnz L_slow_loop
    s_add_u32 s57, s57, 1048576
    s_branch L_flag_done
L_codeend:
    s_endpgm
.fill (L_pc3 + 12288 - .) / 4, 4, 0xbf810000
.section .rodata,"a"
.p2align 6
.amdhsa_kernel standalone__glu_gated_geglu__sampling_kernel
  .amdhsa_next_free_vgpr 256
  .amdhsa_next_free_sgpr 100
  .amdhsa_accum_offset 256
  .amdhsa_group_segment_fixed_size 0
  .amdhsa_kernarg_size 56
  .amdhsa_user_sgpr_count 2
  .amdhsa_user_sgpr_kernarg_segment_ptr 1
  .amdhsa_system_sgpr_workgroup_id_x 1
  .amdhsa_float_denorm_mode_32 3
.end_amdhsa_kernel
```
